```python
import torch

def _softmax(x, axis=-1):
    return torch.softmax(x, dim=axis)
def _gelu(x):
    return torch.nn.functional.gelu(x, approximate="tanh")
def _silu(x):
    return torch.nn.functional.silu(x)
def _sigmoid(x):
    return torch.sigmoid(x)
def _layernorm(x, axis=-1, eps=1e-5):
    m = x.mean(dim=axis, keepdim=True)
    v = x.var(dim=axis, keepdim=True, unbiased=False)
    return (x - m) / torch.sqrt(v + eps)
def _scatter_add(tgt, idx, src, axis=0):
    return tgt.clone().index_add_(axis, idx, src)
def _segment_sum(src, seg, n):
    out = torch.zeros((n,) + src.shape[1:], dtype=src.dtype)
    return out.index_add_(0, seg, src)
def _pad(x, pw):
    flat = tuple(v for pair in reversed(pw) for v in pair)
    return torch.nn.functional.pad(x, flat)

kernel_name = 'sequential_preLN__linear_attn_block__dense_activation_squared_relu__prompt'

def setup_inputs():

    _w = (lambda a: (lambda t: t.to(torch.bfloat16) if t.is_floating_point() else t)(torch.as_tensor(a)))
    def _A_setup():
        B, S, D = 1, 2048, 640
        return {
            "x": _w((lambda *s: torch.randn(*s, dtype=torch.bfloat16) * 0.05)(B, S, D)),
            "wqkv": _w((lambda *s: torch.randn(*s, dtype=torch.bfloat16) * 0.1)(D, 3 * D)),
            "wo": _w((lambda *s: torch.randn(*s, dtype=torch.bfloat16) * 0.05)(D, D)),
        }
    _A_in = _A_setup()

    def _B_setup():
        B, S, D, F = 1, 2048, 640, 1536
        return {
            "x": _w((lambda *s: torch.randn(*s, dtype=torch.bfloat16) * 0.05)(B, S, D)),
            "w1": _w((lambda *s: torch.randn(*s, dtype=torch.bfloat16) * 0.05)(D, F)),
            "b1": _w((lambda *s: torch.randn(*s, dtype=torch.bfloat16) * 0.4)(F)),
            "w2": _w((lambda *s: torch.randn(*s, dtype=torch.bfloat16) * 0.05)(F, D)),
            "b2": _w((lambda *s: torch.randn(*s, dtype=torch.bfloat16) * 1.6)(D)),
        }
    _B_in = _B_setup()

    return {
        "A_x": _A_in["x"],
        "A_wqkv": _A_in["wqkv"],
        "A_wo": _A_in["wo"],
        "B_x": _B_in["x"],
        "B_w1": _B_in["w1"],
        "B_b1": _B_in["b1"],
        "B_w2": _B_in["w2"],
        "B_b2": _B_in["b2"],
    }

def reference(A_x, A_wqkv, A_wo, B_x, B_w1, B_b1, B_w2, B_b2):
    def _A_ref(x, wqkv, wo):
        B, S, D = x.shape
        H = 32; Dh = D // H
        qkv = (lambda x, *d: x.permute(*d))((x @ wqkv).reshape(B, S, 3, H, Dh), 2, 0, 3, 1, 4)
        q, k, v = qkv[0], qkv[1], qkv[2]
        phi = lambda t: torch.where(t > 0, t + 1, torch.exp(t)) + 1e-6
        pq, pk = phi(q), phi(k)
        kv = torch.einsum("bhsd,bhse->bhde", pk, v)
        z = torch.einsum("bhsd->bhd", pk)
        num = torch.einsum("bhqd,bhde->bhqe", pq, kv)
        den = torch.einsum("bhqd,bhd->bhq", pq, z)[..., None] + 1e-6
        o = num / den
        return (lambda x, *d: x.permute(*d))(o, 0, 2, 1, 3).reshape(B, S, D) @ wo

    def _B_ref(x, w1, b1, w2, b2):
        h = torch.einsum("bsd,df->bsf", x, w1) + b1
        zero = torch.zeros_like(h)
        r = torch.where(h > zero, h, zero)
        h = r * r
        out = torch.einsum("bsf,fd->bsd", h, w2) + b2
        return out

    x = A_x
    h = x + _A_ref(_layernorm(x, axis=-1), A_wqkv, A_wo)
    h2 = h + _B_ref(_layernorm(h, axis=-1), B_w1, B_b1, B_w2, B_b2)
    return h2
```

```asm
; @launch grid=(256,1,1) block=(256,1,1) lds=163840
.amdgcn_target "amdgcn-amd-amdhsa--gfx950"
.text
.globl sequential_preLN__linear_attn_block__dense_activation_squared_relu__prompt_kernel
.p2align 8
.type sequential_preLN__linear_attn_block__dense_activation_squared_relu__prompt_kernel,@function
sequential_preLN__linear_attn_block__dense_activation_squared_relu__prompt_kernel:
    s_cmp_ge_u32 s2, 256
    s_cbranch_scc1 L_end
    s_load_dwordx4 s[4:7], s[0:1], 0
    s_cmp_ge_u32 s2, 8
    s_cbranch_scc1 CW_skip
    s_getpc_b64 s[60:61]
CW_pc:
    v_lshlrev_b32 v33, 7, v0
    v_min_u32 v33, L_end-CW_pc, v33
    global_load_dword v35, v33, s[60:61]
CW_skip:
    v_lshrrev_b32 v2, 6, v0
    v_and_b32 v1, 63, v0
    v_readfirstlane_b32 s26, v2
    s_and_b32 s27, s2, 7
    s_bfe_u32 s53, s2, 0x10003
    s_lshl1_add_u32 s30, s27, s53
    s_lshr_b32 s31, s2, 4
    v_lshrrev_b32 v24, 4, v1
    v_lshlrev_b32 v26, 2, v24
    v_and_b32 v25, 15, v1
    v_xor_b32 v25, v25, v26
    v_min_u32 v25, 14, v25
    v_mul_u32_u24 v26, 52, v25
    v_lshrrev_b32 v26, 8, v26
    v_add_u32 v27, 1, v26
    v_cmp_eq_u32 vcc, 2, v26
    s_nop 1
    v_cndmask_b32 v27, v27, 0, vcc
    v_mul_u32_u24 v27, 80, v27
    v_mul_u32_u24 v26, 5, v26
    v_sub_u32 v25, v25, v26
    v_mul_u32_u24 v24, 240, v24
    v_add3_u32 v25, v25, v27, v24
    v_lshlrev_b32 v6, 4, v25
    s_mul_i32 s56, s30, 10
    s_add_u32 s56, s56, s26
    s_mul_i32 s56, s56, 15360
    s_mul_i32 s53, s31, 80
    s_add_u32 s56, s56, s53
    s_add_u32 s57, s56, 61440
    s_add_u32 s58, s56, 122880
    s_cmp_ge_u32 s26, 2
    s_cselect_b32 s58, 0x7fffffff, s58
    s_lshl_b32 s83, s26, 10
    s_mov_b32 s38, 2457600
    s_mov_b32 s39, 0x00020000
    s_mov_b32 m0, s83
    s_waitcnt lgkmcnt(0)
    s_mov_b32 s36, s6
    s_and_b32 s37, s7, 0xffff
    buffer_load_dwordx4 v6, s[36:39], s56 offen lds
    s_add_u32 m0, s83, 4096
    s_nop 0
    buffer_load_dwordx4 v6, s[36:39], s57 offen lds
    s_add_u32 m0, s83, 8192
    s_nop 0
    buffer_load_dwordx4 v6, s[36:39], s58 offen lds
    s_load_dwordx8 s[8:15], s[0:1], 16
    s_load_dwordx8 s[16:23], s[0:1], 48
    s_load_dwordx2 s[24:25], s[0:1], 80
    s_memrealtime s[94:95]
    v_lshlrev_b32 v2, 4, v1
    s_and_b32 s53, s31, 1
    s_lshl1_add_u32 s28, s30, s53
    s_lshr_b32 s29, s31, 1
    s_mul_i32 s68, s30, 5
    s_cmp_ge_u32 s26, 2
    s_cselect_b32 s69, 1, 0
    s_mov_b32 s67, 0
    v_lshlrev_b32 v34, 7, v1
    s_lshl_b32 s52, s30, 4
    s_add_u32 s52, s52, s31
    s_lshl_b32 s52, s52, 2
    s_add_u32 s52, s52, s26
    s_mul_i32 s52, s52, 2560
    s_mov_b32 s32, s4
    s_and_b32 s33, s5, 0xffff
    s_mov_b32 s34, 2621440
    s_mov_b32 s35, 0x00020000
    s_mov_b64 exec, 0xfffff
    buffer_load_dword v35, v34, s[32:35], s52 offen
    s_mov_b64 exec, -1
    v_lshrrev_b32 v24, 3, v1
    v_and_b32 v25, 7, v1
    v_lshrrev_b32 v26, 1, v24
    v_xor_b32 v27, v25, v26
    v_xor_b32 v28, 4, v27
    s_lshl_b32 s54, s30, 7
    s_lshl_b32 s53, s26, 5
    s_add_u32 s54, s54, s53
    v_add_u32 v24, s54, v24
    v_mul_u32_u24 v24, 1280, v24
    v_lshl_add_u32 v4, v27, 4, v24
    v_lshl_add_u32 v5, v28, 4, v24
    v_add_u32 v5, 10240, v5
    s_mul_i32 s59, s26, 28672
    s_add_u32 s59, s59, 12288
    s_waitcnt lgkmcnt(0)
    s_mov_b32 s48, s12
    s_and_b32 s49, s13, 0xffff
    s_mov_b32 s50, 1966080
    s_mov_b32 s51, 0x00020000
    s_lshl_b32 s53, s2, 2
    s_add_u32 s53, s53, s26
    s_mul_i32 s53, s53, 1920
    s_mov_b64 exec, 0x7fff
    buffer_load_dword v35, v34, s[48:51], s53 offen
    s_mov_b64 exec, -1
    s_mov_b32 s44, s22
    s_and_b32 s45, s23, 0xffff
    s_mov_b32 s46, 256
    s_mov_b32 s47, 0x00020000
    s_xor_b32 s53, s2, 2
    s_or_b32 s53, s53, s26
    s_cmp_lg_u32 s53, 0
    s_cbranch_scc1 N_skip
    v_mov_b32 v24, s94
    v_mov_b32 v25, s95
    v_mov_b32 v26, 0
    s_mov_b64 exec, 1
    buffer_store_dwordx2 v[24:25], v26, s[44:47], 0 offen sc1
    s_mov_b64 exec, -1
N_skip:
    s_mov_b32 s40, s24
    s_and_b32 s41, s25, 0xffff
    s_mov_b32 s42, 18724864
    s_mov_b32 s43, 0x00020000
    v_lshrrev_b32 v24, 3, v1
    v_add_u32 v24, 0, v24
    v_and_b32 v26, 12, v24
    v_lshlrev_b32 v26, 1, v26
    v_lshrrev_b32 v27, 4, v24
    v_lshlrev_b32 v27, 2, v27
    v_and_b32 v25, 3, v24
    v_or3_b32 v25, v25, v26, v27
    v_bfe_u32 v26, v1, 1, 2
    v_bfe_u32 v27, v24, 1, 2
    v_xor_b32 v26, v26, v27
    v_and_b32 v27, 1, v1
    v_lshl_or_b32 v26, v26, 1, v27
    v_mul_u32_u24 v25, 1280, v25
    v_lshl_add_u32 v44, v26, 4, v25
    v_lshrrev_b32 v24, 3, v1
    v_add_u32 v24, 8, v24
    v_and_b32 v26, 12, v24
    v_lshlrev_b32 v26, 1, v26
    v_lshrrev_b32 v27, 4, v24
    v_lshlrev_b32 v27, 2, v27
    v_and_b32 v25, 3, v24
    v_or3_b32 v25, v25, v26, v27
    v_bfe_u32 v26, v1, 1, 2
    v_bfe_u32 v27, v24, 1, 2
    v_xor_b32 v26, v26, v27
    v_and_b32 v27, 1, v1
    v_lshl_or_b32 v26, v26, 1, v27
    v_mul_u32_u24 v25, 1280, v25
    v_lshl_add_u32 v45, v26, 4, v25
    v_lshrrev_b32 v24, 3, v1
    v_add_u32 v24, 16, v24
    v_and_b32 v26, 12, v24
    v_lshlrev_b32 v26, 1, v26
    v_lshrrev_b32 v27, 4, v24
    v_lshlrev_b32 v27, 2, v27
    v_and_b32 v25, 3, v24
    v_or3_b32 v25, v25, v26, v27
    v_bfe_u32 v26, v1, 1, 2
    v_bfe_u32 v27, v24, 1, 2
    v_xor_b32 v26, v26, v27
    v_and_b32 v27, 1, v1
    v_lshl_or_b32 v26, v26, 1, v27
    v_mul_u32_u24 v25, 1280, v25
    v_lshl_add_u32 v46, v26, 4, v25
    v_lshrrev_b32 v24, 3, v1
    v_add_u32 v24, 24, v24
    v_and_b32 v26, 12, v24
    v_lshlrev_b32 v26, 1, v26
    v_lshrrev_b32 v27, 4, v24
    v_lshlrev_b32 v27, 2, v27
    v_and_b32 v25, 3, v24
    v_or3_b32 v25, v25, v26, v27
    v_bfe_u32 v26, v1, 1, 2
    v_bfe_u32 v27, v24, 1, 2
    v_xor_b32 v26, v26, v27
    v_and_b32 v27, 1, v1
    v_lshl_or_b32 v26, v26, 1, v27
    v_mul_u32_u24 v25, 1280, v25
    v_lshl_add_u32 v47, v26, 4, v25
    s_lshl_b32 s80, s2, 1
    s_add_u32 s80, s80, s26
    s_cmp_lt_u32 s2, 240
    s_cselect_b32 s90, 2, 0
    s_and_b32 s53, s2, 1
    s_add_u32 s53, s53, 2
    s_cmp_eq_u32 s53, s26
    s_cselect_b32 s91, 1, 0
    s_cmp_lt_u32 s2, 200
    s_cselect_b32 s91, s91, 0
    s_cmp_lt_u32 s26, 2
    s_cselect_b32 s90, s90, s91
    s_cselect_b32 s80, s80, s2
    s_cselect_b64 s[48:49], s[16:17], s[8:9]
    s_cselect_b32 s86, 12, 5
    s_mov_b32 s85, 12189696
    s_cselect_b32 s85, 13008896, s85
    s_mov_b32 s50, 819200
    s_cselect_b32 s50, 1966080, s50
    s_and_b32 s49, s49, 0xffff
    s_mov_b32 s51, 0x00020000
    s_mul_i32 s78, s80, 6554
    s_lshr_b32 s78, s78, 16
    s_mul_i32 s79, s78, 10
    s_sub_u32 s79, s80, s79
    s_mul_i32 s87, s78, 40960
    s_lshl_b32 s88, s79, 7
    s_add_u32 s87, s87, s88
    s_lshl_b32 s81, s26, 12
    s_add_u32 s81, s81, 126976
    s_cmp_eq_u32 s90, 0
    s_cselect_b32 s87, 0x7fffffff, s87
    s_cmp_lg_u32 s90, 1
    s_cbranch_scc1 E_no
    s_add_u32 m0, s81, 0
    s_nop 0
    buffer_load_dwordx4 v44, s[48:51], s87 offen lds
    s_add_u32 m0, s81, 1024
    s_nop 0
    buffer_load_dwordx4 v45, s[48:51], s87 offen lds
    s_add_u32 m0, s81, 2048
    s_nop 0
    buffer_load_dwordx4 v46, s[48:51], s87 offen lds
    s_add_u32 m0, s81, 3072
    s_nop 0
    buffer_load_dwordx4 v47, s[48:51], s87 offen lds
    s_mov_b32 s87, 0x7fffffff
E_no:
    s_add_u32 m0, s59, 0
    s_movk_i32 s63, 0
    buffer_load_dwordx4 v4, s[32:35], s63 offen lds
    s_add_u32 m0, s59, 1024
    s_nop 0
    buffer_load_dwordx4 v5, s[32:35], s63 offen lds
    s_add_u32 m0, s59, 2048
    s_movk_i32 s63, 20480
    buffer_load_dwordx4 v4, s[32:35], s63 offen lds
    s_add_u32 m0, s59, 3072
    s_nop 0
    buffer_load_dwordx4 v5, s[32:35], s63 offen lds
    s_add_u32 m0, s59, 4096
    s_movk_i32 s63, 128
    buffer_load_dwordx4 v4, s[32:35], s63 offen lds
    s_add_u32 m0, s59, 5120
    s_nop 0
    buffer_load_dwordx4 v5, s[32:35], s63 offen lds
    s_mul_i32 s84, s86, 20
    s_mul_i32 s88, s78, 5
    s_mul_i32 s60, s78, 43
    s_lshr_b32 s60, s60, 9
    s_mul_i32 s60, s60, 1
    s_cmp_lt_u32 s26, 2
    s_cselect_b32 s60, s60, 0
    s_cselect_b32 s61, 4, 0
    s_add_u32 s88, s88, s60
    s_add_u32 s84, s84, s61
    s_lshl_b32 s60, s79, 2
    s_add_u32 s60, s60, 0
    s_mul_i32 s61, s60, 52
    s_lshr_b32 s61, s61, 8
    s_mul_i32 s62, s61, 5
    s_sub_u32 s60, s60, s62
    s_mul_i32 s61, s61, s84
    s_add_u32 s60, s60, s61
    s_add_u32 s60, s60, s88
    s_lshl_b32 s60, s60, 10
    s_add_u32 s16, s60, s85
    s_lshl_b32 s60, s79, 2
    s_add_u32 s60, s60, 1
    s_mul_i32 s61, s60, 52
    s_lshr_b32 s61, s61, 8
    s_mul_i32 s62, s61, 5
    s_sub_u32 s60, s60, s62
    s_mul_i32 s61, s61, s84
    s_add_u32 s60, s60, s61
    s_add_u32 s60, s60, s88
    s_lshl_b32 s60, s60, 10
    s_add_u32 s17, s60, s85
    s_lshl_b32 s60, s79, 2
    s_add_u32 s60, s60, 2
    s_mul_i32 s61, s60, 52
    s_lshr_b32 s61, s61, 8
    s_mul_i32 s62, s61, 5
    s_sub_u32 s60, s60, s62
    s_mul_i32 s61, s61, s84
    s_add_u32 s60, s60, s61
    s_add_u32 s60, s60, s88
    s_lshl_b32 s60, s60, 10
    s_add_u32 s89, s60, s85
    s_lshl_b32 s60, s79, 2
    s_add_u32 s60, s60, 3
    s_mul_i32 s61, s60, 52
    s_lshr_b32 s61, s61, 8
    s_mul_i32 s62, s61, 5
    s_sub_u32 s60, s60, s62
    s_mul_i32 s61, s61, s84
    s_add_u32 s60, s60, s61
    s_add_u32 s60, s60, s88
    s_lshl_b32 s60, s60, 10
    s_add_u32 s91, s60, s85
    s_cmp_eq_u32 s90, 0
    s_cselect_b32 s16, 0x7fffffff, s16
    s_cselect_b32 s17, 0x7fffffff, s17
    s_cselect_b32 s89, 0x7fffffff, s89
    s_cselect_b32 s91, 0x7fffffff, s91
    v_lshrrev_b32 v24, 4, v1
    s_and_b32 s60, s26, 1
    s_lshl_b32 s60, s60, 2
    v_add_u32 v24, s60, v24
    v_bfe_u32 v25, v1, 2, 2
    v_lshlrev_b32 v26, 1, v25
    v_xor_b32 v26, v26, v24
    v_lshlrev_b32 v25, 8, v25
    v_lshl_or_b32 v25, v26, 5, v25
    v_and_b32 v26, 3, v1
    v_lshl_or_b32 v25, v26, 3, v25
    s_lshr_b32 s60, s26, 1
    s_lshl_b32 s61, s60, 11
    v_add_u32 v7, s61, v25
    v_and_b32 v25, 15, v1
    v_lshlrev_b32 v26, 2, v0
    v_add_u32 v15, 162048, v26
    v_add_u32 v33, 162048, v2
    v_cmp_le_u32 s[70:71], 5, v24
    v_cmp_eq_u32 s[72:73], 7, v24
    v_cmp_le_u32 s[74:75], 8, v25
    v_add_u32 v26, -5, v24
    v_cndmask_b32 v26, v24, v26, s[70:71]
    v_lshlrev_b32 v26, 10, v26
    v_lshl_or_b32 v14, v25, 4, v26
    s_and_b64 s[74:75], s[74:75], s[72:73]
    s_not_b64 s[74:75], s[74:75]
    s_add_u32 s61, s68, s60
    s_mul_i32 s62, s31, 153600
    s_add_u32 s82, s62, 16201728
    v_mov_b32 v20, 0x3f803f80
    v_mov_b32 v21, 0x3f803f80
    v_mov_b32 v22, 0x3f803f80
    v_mov_b32 v23, 0x3f803f80
    s_add_u32 s62, s61, 0
    s_lshr_b32 s63, s62, 2
    s_and_b32 s62, s62, 3
    s_lshl_b32 s62, s62, 8
    s_mul_i32 s64, s63, 5120
    s_add_u32 s64, s64, s62
    s_lshr_b32 s65, s63, 1
    s_mul_i32 s65, s65, 5120
    s_add_u32 s65, s65, s62
    s_add_u32 s65, s65, 102400
    s_and_b32 s63, s63, 1
    s_lshl_b32 s62, s63, 7
    s_add_u32 s62, s62, s65
    s_add_u32 s62, s62, 2048
    s_lshl_b32 s63, s63, 11
    s_add_u32 s65, s65, s63
    v_mov_b32 v24, s64
    v_mov_b32 v25, s65
    v_mov_b32 v26, s62
    v_cndmask_b32 v24, v24, v25, s[70:71]
    v_cndmask_b32 v24, v24, v26, s[72:73]
    v_add_u32 v48, v24, v14
    s_add_u32 s62, s61, 2
    s_lshr_b32 s63, s62, 2
    s_and_b32 s62, s62, 3
    s_lshl_b32 s62, s62, 8
    s_mul_i32 s64, s63, 5120
    s_add_u32 s64, s64, s62
    s_lshr_b32 s65, s63, 1
    s_mul_i32 s65, s65, 5120
    s_add_u32 s65, s65, s62
    s_add_u32 s65, s65, 102400
    s_and_b32 s63, s63, 1
    s_lshl_b32 s62, s63, 7
    s_add_u32 s62, s62, s65
    s_add_u32 s62, s62, 2048
    s_lshl_b32 s63, s63, 11
    s_add_u32 s65, s65, s63
    v_mov_b32 v24, s64
    v_mov_b32 v25, s65
    v_mov_b32 v26, s62
    v_cndmask_b32 v24, v24, v25, s[70:71]
    v_cndmask_b32 v24, v24, v26, s[72:73]
    v_add_u32 v49, v24, v14
    s_add_u32 s62, s61, 4
    s_lshr_b32 s63, s62, 2
    s_and_b32 s62, s62, 3
    s_lshl_b32 s62, s62, 8
    s_mul_i32 s64, s63, 5120
    s_add_u32 s64, s64, s62
    s_lshr_b32 s65, s63, 1
    s_mul_i32 s65, s65, 5120
    s_add_u32 s65, s65, s62
    s_add_u32 s65, s65, 102400
    s_and_b32 s63, s63, 1
    s_lshl_b32 s62, s63, 7
    s_add_u32 s62, s62, s65
    s_add_u32 s62, s62, 2048
    s_lshl_b32 s63, s63, 11
    s_add_u32 s65, s65, s63
    v_mov_b32 v24, s64
    v_mov_b32 v25, s65
    v_mov_b32 v26, s62
    v_cndmask_b32 v24, v24, v25, s[70:71]
    v_cndmask_b32 v24, v24, v26, s[72:73]
    v_add_u32 v50, v24, v14
    s_cmp_eq_u32 s69, 1
    s_cselect_b32 s56, 0x7fffffff, s82
    s_cmp_eq_u32 s67, 1
    s_cselect_b32 s57, 0x7fffffff, s82
    s_lshl_b32 s62, s31, 4
    s_add_u32 s62, s62, s30
    s_lshl_b32 s55, s62, 9
    s_add_u32 s55, s55, 16070656
    s_lshl_b32 s97, s62, 3
    s_add_u32 s97, s97, 16068608
    v_mov_b32 v244, 0
    s_waitcnt vmcnt(8)
    s_barrier
    ds_read_b64_tr_b16 v[52:53], v7 offset:0
    ds_read_b64_tr_b16 v[54:55], v7 offset:1024
    ds_read_b64_tr_b16 v[56:57], v7 offset:4096
    ds_read_b64_tr_b16 v[58:59], v7 offset:5120
    ds_read_b64_tr_b16 v[60:61], v7 offset:8192
    ds_read_b64_tr_b16 v[62:63], v7 offset:9216
    buffer_load_dwordx2 v[242:243], v244, s[44:47], 0 offen sc1
    s_mov_b64 exec, s[74:75]
    s_waitcnt lgkmcnt(4)
    buffer_store_dwordx4 v[52:55], v48, s[40:43], s57 offen sc1
    s_waitcnt lgkmcnt(2)
    buffer_store_dwordx4 v[56:59], v49, s[40:43], s57 offen sc1
    s_waitcnt lgkmcnt(0)
    buffer_store_dwordx4 v[60:63], v50, s[40:43], s56 offen sc1
    s_mov_b64 exec, -1
    v_dot2_f32_bf16 v68, v52, v20, 0
    v_dot2_f32_bf16 v69, v53, v20, 0
    v_dot2_f32_bf16 v70, v54, v20, 0
    v_dot2_f32_bf16 v71, v55, v20, 0
    v_dot2c_f32_bf16 v68, v56, v20
    v_dot2c_f32_bf16 v69, v57, v20
    v_dot2c_f32_bf16 v70, v58, v20
    v_dot2c_f32_bf16 v71, v59, v20
    v_dot2c_f32_bf16 v68, v60, v20
    v_dot2c_f32_bf16 v69, v61, v20
    v_dot2c_f32_bf16 v70, v62, v20
    v_dot2c_f32_bf16 v71, v63, v20
    s_add_u32 m0, s59, 6144
    s_movk_i32 s63, 20608
    buffer_load_dwordx4 v4, s[32:35], s63 offen lds
    s_add_u32 m0, s59, 7168
    s_nop 0
    buffer_load_dwordx4 v5, s[32:35], s63 offen lds
    s_add_u32 m0, s59, 8192
    s_movk_i32 s63, 256
    buffer_load_dwordx4 v4, s[32:35], s63 offen lds
    s_add_u32 m0, s59, 9216
    s_nop 0
    buffer_load_dwordx4 v5, s[32:35], s63 offen lds
    v_pk_add_f32 v[68:69], v[68:69], v[70:71]
    v_add_f32 v68, v68, v69
    ds_write_b32 v15, v68
    s_waitcnt lgkmcnt(0)
    s_barrier
    s_cmp_lg_u32 s26, 1
    s_cbranch_scc1 CS_skip
    s_mov_b64 exec, 0xffffffff
    ds_read_b128 v[52:55], v33
    ds_read_b128 v[56:59], v33 offset:512
    s_waitcnt lgkmcnt(0)
    v_pk_add_f32 v[52:53], v[52:53], v[56:57]
    v_pk_add_f32 v[54:55], v[54:55], v[58:59]
    buffer_store_dwordx4 v[52:55], v2, s[40:43], s55 offen sc1
    s_mov_b64 exec, -1
CS_skip:
    v_and_b32 v68, 15, v1
    v_lshrrev_b32 v69, 4, v1
    v_bfe_u32 v70, v1, 1, 3
    v_xor_b32 v70, v69, v70
    v_lshl_add_u32 v70, v68, 3, v70
    v_lshlrev_b32 v70, 4, v70
    v_add_u32 v8, s59, v70
    v_xor_b32 v9, 64, v8
    s_add_u32 m0, s59, 10240
    s_movk_i32 s63, 20736
    buffer_load_dwordx4 v4, s[32:35], s63 offen lds
    v_lshlrev_b32 v239, 3, v68
    v_lshrrev_b32 v68, 2, v1
    v_bfe_u32 v69, v1, 3, 2
    v_lshlrev_b32 v68, 7, v68
    v_lshl_or_b32 v68, v69, 5, v68
    v_and_b32 v69, 3, v1
    v_lshl_or_b32 v68, v69, 3, v68
    v_xor_b32 v222, 0, v68
    s_add_u32 m0, s59, 11264
    s_nop 0
    buffer_load_dwordx4 v5, s[32:35], s63 offen lds
    v_add_u32 v222, s81, v222
    v_xor_b32 v223, 32, v68
    v_add_u32 v223, s81, v223
    v_xor_b32 v224, 64, v68
    v_add_u32 v224, s81, v224
    v_xor_b32 v225, 96, v68
    v_add_u32 v225, s81, v225
    v_mov_b64 v[70:71], 0
    s_add_u32 m0, s59, 12288
    s_movk_i32 s63, 384
    buffer_load_dwordx4 v4, s[32:35], s63 offen lds
    v_mov_b64 v[72:73], 0
    v_lshlrev_b32 v68, 4, v0
    v_min_u32 v69, 2288, v68
    v_add_u32 v68, 155648, v68
    v_add_u32 v69, 159744, v69
    ds_write_b128 v68, v[70:73]
    ds_write_b128 v69, v[70:73]
    v_mov_b32 v10, v2
    s_add_u32 m0, s59, 13312
    s_nop 0
    buffer_load_dwordx4 v5, s[32:35], s63 offen lds
    v_add_u32 v11, 51200, v2
    v_add_u32 v12, 102400, v2
    s_lshl_b32 s66, s31, 7
    s_add_u32 s66, s66, 16068608
    s_lshl_b32 s67, s31, 2
    s_add_u32 s67, s67, s26
    s_lshl_b32 s67, s67, 11
    s_add_u32 s67, s67, 16070656
    s_add_u32 m0, s59, 14336
    s_movk_i32 s63, 20864
    buffer_load_dwordx4 v4, s[32:35], s63 offen lds
    s_mul_i32 s69, s26, 5120
    s_add_u32 s82, s82, s69
    s_lshl_b32 s9, s30, 4
    s_add_u32 s9, s9, s31
    s_lshl_b32 s9, s9, 3
    s_add_u32 s9, s9, 16056320
    s_getreg_b32 s92, hwreg(HW_REG_XCC_ID, 0, 4)
    s_mul_i32 s65, s31, 57344
    s_add_u32 m0, s59, 15360
    s_nop 0
    buffer_load_dwordx4 v5, s[32:35], s63 offen lds
    s_add_u32 s65, s65, 15007744
    v_lshlrev_b32 v227, 4, v0
    v_add_u32 v227, s65, v227
    v_cmp_gt_u32 vcc, 210, v0
    s_nop 0
    s_mov_b64 s[10:11], vcc
    s_mul_i32 s8, s30, 3584
    v_mov_b64 v[64:65], -1
    v_mov_b64 v[66:67], -1
    s_waitcnt vmcnt(13)
    s_mov_b32 s96, 0
N_l:
    v_readfirstlane_b32 s94, v242
    v_readfirstlane_b32 s95, v243
    s_nop 0
    s_or_b32 s62, s94, s95
    s_cmp_lg_u32 s62, 0
    s_cbranch_scc1 N_d
    buffer_load_dwordx2 v[242:243], v244, s[44:47], 0 offen sc1
    s_waitcnt vmcnt(0)
    s_add_u32 s96, s96, 1
    s_cmp_lt_u32 s96, 40000
    s_cbranch_scc1 N_l
N_d:
    s_waitcnt vmcnt(6)
    s_barrier
    s_cmp_lg_u32 s26, 0
    s_cbranch_scc1 nf_1
    s_mov_b64 exec, 1
    buffer_store_dwordx2 v[242:243], v244, s[40:43], s97 offen sc1
    s_mov_b64 exec, -1
nf_1:
    s_mov_b64 exec, s[10:11]
    buffer_store_dwordx4 v[64:67], v227, s[40:43], s8 offen sc1
    s_mov_b64 exec, -1
    s_cmp_lg_u32 s90, 1
    s_cbranch_scc1 E_nob
    ds_read_b64_tr_b16 v[76:77], v222 offset:0
    ds_read_b64_tr_b16 v[78:79], v222 offset:2048
    ds_read_b64_tr_b16 v[80:81], v223 offset:0
    ds_read_b64_tr_b16 v[82:83], v223 offset:2048
    ds_read_b64_tr_b16 v[84:85], v224 offset:0
    ds_read_b64_tr_b16 v[86:87], v224 offset:2048
    ds_read_b64_tr_b16 v[88:89], v225 offset:0
    ds_read_b64_tr_b16 v[90:91], v225 offset:2048
    s_waitcnt lgkmcnt(6)
    buffer_store_dwordx4 v[76:79], v2, s[40:43], s16 offen sc1
    s_mov_b32 s16, 0x7fffffff
    s_waitcnt lgkmcnt(4)
    buffer_store_dwordx4 v[80:83], v2, s[40:43], s17 offen sc1
    s_mov_b32 s17, 0x7fffffff
    s_waitcnt lgkmcnt(2)
    buffer_store_dwordx4 v[84:87], v2, s[40:43], s89 offen sc1
    s_mov_b32 s89, 0x7fffffff
    s_waitcnt lgkmcnt(0)
    buffer_store_dwordx4 v[88:91], v2, s[40:43], s91 offen sc1
    s_mov_b32 s91, 0x7fffffff
E_nob:
    s_add_u32 m0, s59, 16384
    s_movk_i32 s63, 512
    buffer_load_dwordx4 v4, s[32:35], s63 offen lds
    s_add_u32 m0, s59, 17408
    s_nop 0
    buffer_load_dwordx4 v5, s[32:35], s63 offen lds
    s_add_u32 m0, s59, 18432
    s_movk_i32 s63, 20992
    buffer_load_dwordx4 v4, s[32:35], s63 offen lds
    s_add_u32 m0, s59, 19456
    s_nop 0
    buffer_load_dwordx4 v5, s[32:35], s63 offen lds
    s_add_u32 m0, s59, 20480
    s_movk_i32 s63, 640
    buffer_load_dwordx4 v4, s[32:35], s63 offen lds
    s_add_u32 m0, s59, 21504
    s_nop 0
    buffer_load_dwordx4 v5, s[32:35], s63 offen lds
    s_add_u32 m0, s59, 22528
    s_movk_i32 s63, 21120
    buffer_load_dwordx4 v4, s[32:35], s63 offen lds
    s_add_u32 m0, s59, 23552
    s_nop 0
    buffer_load_dwordx4 v5, s[32:35], s63 offen lds
    s_lshl_b32 s62, s95, 4
    s_or_b32 s92, s92, s62
    v_mov_b32 v24, s94
    v_mov_b32 v25, s92
    ds_read_b128 a[0:3], v8 offset:0
    ds_read_b128 a[4:7], v8 offset:2048
    ds_read_b128 a[8:11], v9 offset:0
    ds_read_b128 a[12:15], v9 offset:2048
    ds_read_b128 a[16:19], v8 offset:4096
    ds_read_b128 a[20:23], v8 offset:6144
    ds_read_b128 a[24:27], v9 offset:4096
    ds_read_b128 a[28:31], v9 offset:6144
    s_waitcnt lgkmcnt(4)
    v_mfma_f32_16x16x32_bf16 v[148:151], v[20:23], a[0:3], 0
    s_add_u32 m0, s59, 24576
    s_movk_i32 s63, 768
    v_mfma_f32_16x16x32_bf16 v[214:217], a[0:3], a[0:3], 0
    buffer_load_dwordx4 v4, s[32:35], s63 offen lds
    v_mfma_f32_16x16x32_bf16 v[152:155], v[20:23], a[4:7], 0
    s_add_u32 m0, s59, 25600
    s_nop 0
    v_mfma_f32_16x16x32_bf16 v[218:221], a[4:7], a[4:7], 0
    buffer_load_dwordx4 v5, s[32:35], s63 offen lds
    v_mfma_f32_16x16x32_bf16 v[148:151], v[20:23], a[8:11], v[148:151]
    s_add_u32 m0, s59, 26624
    s_movk_i32 s63, 21248
    v_mfma_f32_16x16x32_bf16 v[214:217], a[8:11], a[8:11], v[214:217]
    buffer_load_dwordx4 v4, s[32:35], s63 offen lds
    v_mfma_f32_16x16x32_bf16 v[152:155], v[20:23], a[12:15], v[152:155]
    s_add_u32 m0, s59, 27648
    s_nop 0
    v_mfma_f32_16x16x32_bf16 v[218:221], a[12:15], a[12:15], v[218:221]
    buffer_load_dwordx4 v5, s[32:35], s63 offen lds
    s_waitcnt vmcnt(17)
    ds_read_b128 a[32:35], v8 offset:8192
    ds_read_b128 a[36:39], v8 offset:10240
    ds_read_b128 a[40:43], v9 offset:8192
    ds_read_b128 a[44:47], v9 offset:10240
    s_waitcnt lgkmcnt(4)
    v_mfma_f32_16x16x32_bf16 v[148:151], v[20:23], a[16:19], v[148:151]
    s_add_u32 m0, s59, 0
    s_movk_i32 s63, 896
    v_mfma_f32_16x16x32_bf16 v[214:217], a[16:19], a[16:19], v[214:217]
    buffer_load_dwordx4 v4, s[32:35], s63 offen lds
    v_mfma_f32_16x16x32_bf16 v[152:155], v[20:23], a[20:23], v[152:155]
    s_add_u32 m0, s59, 1024
    s_nop 0
    v_mfma_f32_16x16x32_bf16 v[218:221], a[20:23], a[20:23], v[218:221]
    buffer_load_dwordx4 v5, s[32:35], s63 offen lds
    v_mfma_f32_16x16x32_bf16 v[148:151], v[20:23], a[24:27], v[148:151]
    s_add_u32 m0, s59, 2048
    s_movk_i32 s63, 21376
    v_mfma_f32_16x16x32_bf16 v[214:217], a[24:27], a[24:27], v[214:217]
    buffer_load_dwordx4 v4, s[32:35], s63 offen lds
    v_mfma_f32_16x16x32_bf16 v[152:155], v[20:23], a[28:31], v[152:155]
    s_add_u32 m0, s59, 3072
    s_nop 0
    v_mfma_f32_16x16x32_bf16 v[218:221], a[28:31], a[28:31], v[218:221]
    buffer_load_dwordx4 v5, s[32:35], s63 offen lds
    s_waitcnt vmcnt(17)
    ds_read_b128 a[48:51], v8 offset:12288
    ds_read_b128 a[52:55], v8 offset:14336
    ds_read_b128 a[56:59], v9 offset:12288
    ds_read_b128 a[60:63], v9 offset:14336
    s_waitcnt lgkmcnt(4)
    v_mfma_f32_16x16x32_bf16 v[148:151], v[20:23], a[32:35], v[148:151]
    s_add_u32 m0, s59, 4096
    s_movk_i32 s63, 1024
    v_mfma_f32_16x16x32_bf16 v[214:217], a[32:35], a[32:35], v[214:217]
    buffer_load_dwordx4 v4, s[32:35], s63 offen lds
    v_mfma_f32_16x16x32_bf16 v[152:155], v[20:23], a[36:39], v[152:155]
    s_add_u32 m0, s59, 5120
    s_nop 0
    v_mfma_f32_16x16x32_bf16 v[218:221], a[36:39], a[36:39], v[218:221]
    buffer_load_dwordx4 v5, s[32:35], s63 offen lds
    v_mfma_f32_16x16x32_bf16 v[148:151], v[20:23], a[40:43], v[148:151]
    s_add_u32 m0, s59, 6144
    s_movk_i32 s63, 21504
    v_mfma_f32_16x16x32_bf16 v[214:217], a[40:43], a[40:43], v[214:217]
    buffer_load_dwordx4 v4, s[32:35], s63 offen lds
    v_mfma_f32_16x16x32_bf16 v[152:155], v[20:23], a[44:47], v[152:155]
    s_add_u32 m0, s59, 7168
    s_nop 0
    v_mfma_f32_16x16x32_bf16 v[218:221], a[44:47], a[44:47], v[218:221]
    buffer_load_dwordx4 v5, s[32:35], s63 offen lds
    s_waitcnt vmcnt(16)
    ds_read_b128 a[64:67], v8 offset:16384
    ds_read_b128 a[68:71], v8 offset:18432
    ds_read_b128 a[72:75], v9 offset:16384
    ds_read_b128 a[76:79], v9 offset:18432
    s_waitcnt lgkmcnt(4)
    v_mfma_f32_16x16x32_bf16 v[148:151], v[20:23], a[48:51], v[148:151]
    s_add_u32 m0, s59, 8192
    s_movk_i32 s63, 1152
    v_mfma_f32_16x16x32_bf16 v[214:217], a[48:51], a[48:51], v[214:217]
    buffer_load_dwordx4 v4, s[32:35], s63 offen lds
    v_mfma_f32_16x16x32_bf16 v[152:155], v[20:23], a[52:55], v[152:155]
    s_add_u32 m0, s59, 9216
    s_nop 0
    v_mfma_f32_16x16x32_bf16 v[218:221], a[52:55], a[52:55], v[218:221]
    buffer_load_dwordx4 v5, s[32:35], s63 offen lds
    v_mfma_f32_16x16x32_bf16 v[148:151], v[20:23], a[56:59], v[148:151]
    s_add_u32 m0, s59, 10240
    s_movk_i32 s63, 21632
    v_mfma_f32_16x16x32_bf16 v[214:217], a[56:59], a[56:59], v[214:217]
    buffer_load_dwordx4 v4, s[32:35], s63 offen lds
    v_mfma_f32_16x16x32_bf16 v[152:155], v[20:23], a[60:63], v[152:155]
    s_add_u32 m0, s59, 11264
    s_nop 0
    v_mfma_f32_16x16x32_bf16 v[218:221], a[60:63], a[60:63], v[218:221]
    buffer_load_dwordx4 v5, s[32:35], s63 offen lds
    s_waitcnt vmcnt(16)
    ds_read_b128 a[80:83], v8 offset:20480
    ds_read_b128 a[84:87], v8 offset:22528
    ds_read_b128 a[88:91], v9 offset:20480
    ds_read_b128 a[92:95], v9 offset:22528
    s_waitcnt lgkmcnt(4)
    v_mfma_f32_16x16x32_bf16 v[148:151], v[20:23], a[64:67], v[148:151]
    s_add_u32 m0, s81, 0
    s_nop 0
    v_mfma_f32_16x16x32_bf16 v[214:217], a[64:67], a[64:67], v[214:217]
    buffer_load_dwordx4 v44, s[48:51], s87 offen lds
    v_mfma_f32_16x16x32_bf16 v[152:155], v[20:23], a[68:71], v[152:155]
    s_add_u32 m0, s81, 1024
    s_nop 0
    v_mfma_f32_16x16x32_bf16 v[218:221], a[68:71], a[68:71], v[218:221]
    buffer_load_dwordx4 v45, s[48:51], s87 offen lds
    v_mfma_f32_16x16x32_bf16 v[148:151], v[20:23], a[72:75], v[148:151]
    s_add_u32 m0, s81, 2048
    s_nop 0
    v_mfma_f32_16x16x32_bf16 v[214:217], a[72:75], a[72:75], v[214:217]
    buffer_load_dwordx4 v46, s[48:51], s87 offen lds
    v_mfma_f32_16x16x32_bf16 v[152:155], v[20:23], a[76:79], v[152:155]
    s_add_u32 m0, s81, 3072
    s_nop 0
    v_mfma_f32_16x16x32_bf16 v[218:221], a[76:79], a[76:79], v[218:221]
    buffer_load_dwordx4 v47, s[48:51], s87 offen lds
    s_waitcnt vmcnt(16)
    ds_read_b128 a[96:99], v8 offset:24576
    ds_read_b128 a[100:103], v8 offset:26624
    ds_read_b128 a[104:107], v9 offset:24576
    ds_read_b128 a[108:111], v9 offset:26624
    s_waitcnt lgkmcnt(4)
    v_mfma_f32_16x16x32_bf16 v[148:151], v[20:23], a[80:83], v[148:151]
    v_and_b32 v68, 15, v1
    v_lshrrev_b32 v69, 4, v1
    v_mfma_f32_16x16x32_bf16 v[214:217], a[80:83], a[80:83], v[214:217]
    s_lshl_b32 s64, s26, 7
    v_lshl_add_u32 v16, v68, 2, s64
    v_mfma_f32_16x16x32_bf16 v[152:155], v[20:23], a[84:87], v[152:155]
    v_add_u32 v16, 162048, v16
    v_lshl_add_u32 v17, v69, 4, s64
    v_mfma_f32_16x16x32_bf16 v[218:221], a[84:87], a[84:87], v[218:221]
    v_add_u32 v17, 162048, v17
    v_and_b32 v30, 0x1f0, v2
    v_mfma_f32_16x16x32_bf16 v[148:151], v[20:23], a[88:91], v[148:151]
    s_lshl_b32 s64, s26, 9
    s_add_u32 s64, s64, 153600
    v_mfma_f32_16x16x32_bf16 v[214:217], a[88:91], a[88:91], v[214:217]
    v_add_u32 v30, s64, v30
    v_lshlrev_b32 v31, 2, v68
    v_mfma_f32_16x16x32_bf16 v[152:155], v[20:23], a[92:95], v[152:155]
    v_add_u32 v31, 153600, v31
    v_lshlrev_b32 v32, 4, v69
    v_mfma_f32_16x16x32_bf16 v[218:221], a[92:95], a[92:95], v[218:221]
    v_add_u32 v32, 153920, v32
    v_and_b32 v70, 3, v1
    s_waitcnt vmcnt(12)
    ds_read_b128 a[112:115], v8 offset:0
    ds_read_b128 a[116:119], v8 offset:2048
    ds_read_b128 a[120:123], v9 offset:0
    ds_read_b128 a[124:127], v9 offset:2048
    s_waitcnt lgkmcnt(4)
    v_mfma_f32_16x16x32_bf16 v[148:151], v[20:23], a[96:99], v[148:151]
    v_cmp_eq_u32 s[70:71], 1, v70
    v_cmp_eq_u32 s[72:73], 2, v70
    v_mfma_f32_16x16x32_bf16 v[214:217], a[96:99], a[96:99], v[214:217]
    v_cmp_eq_u32 s[74:75], 3, v70
    v_bfe_u32 v70, v1, 2, 2
    v_mfma_f32_16x16x32_bf16 v[152:155], v[20:23], a[100:103], v[152:155]
    v_cmp_eq_u32 s[60:61], v70, v69
    s_mov_b32 s93, 0x3acccccd
    v_mfma_f32_16x16x32_bf16 v[218:221], a[100:103], a[100:103], v[218:221]
    s_mov_b32 s78, 0x3fb8aa3b
    s_mov_b32 s79, 0x358637bd
    v_mfma_f32_16x16x32_bf16 v[148:151], v[20:23], a[104:107], v[148:151]
    s_mov_b32 s77, s79
    s_mov_b32 s76, s79
    v_mfma_f32_16x16x32_bf16 v[214:217], a[104:107], a[104:107], v[214:217]
    v_lshlrev_b32 v232, 3, v0
    s_lshl_b32 s52, s30, 7
    v_mfma_f32_16x16x32_bf16 v[152:155], v[20:23], a[108:111], v[152:155]
    s_add_u32 s52, s52, 16056320
    s_mov_b32 s53, 16056320
    v_mfma_f32_16x16x32_bf16 v[218:221], a[108:111], a[108:111], v[218:221]
    v_and_b32 v13, 0x37f, v2
    v_add_u32 v13, 106496, v13
    s_waitcnt vmcnt(8)
    ds_read_b128 a[128:131], v8 offset:4096
    ds_read_b128 a[132:135], v8 offset:6144
    ds_read_b128 a[136:139], v9 offset:4096
    ds_read_b128 a[140:143], v9 offset:6144
    s_waitcnt lgkmcnt(4)
    v_mfma_f32_16x16x32_bf16 v[148:151], v[20:23], a[112:115], v[148:151]
    buffer_load_dwordx2 v[28:29], v239, s[40:43], s66 offen sc1
    v_mfma_f32_16x16x32_bf16 v[214:217], a[112:115], a[112:115], v[214:217]
    v_bfe_u32 v69, v1, 4, 1
    v_lshrrev_b32 v70, 5, v1
    v_mfma_f32_16x16x32_bf16 v[152:155], v[20:23], a[116:119], v[152:155]
    v_lshlrev_b32 v70, 8, v70
    v_lshl_or_b32 v70, v68, 4, v70
    v_mfma_f32_16x16x32_bf16 v[218:221], a[116:119], a[116:119], v[218:221]
    v_mul_u32_u24 v236, 20480, v69
    v_add_u32 v236, v236, v70
    v_mfma_f32_16x16x32_bf16 v[148:151], v[20:23], a[120:123], v[148:151]
    v_mul_u32_u24 v238, 53248, v69
    v_add_u32 v238, v238, v70
    v_mfma_f32_16x16x32_bf16 v[214:217], a[120:123], a[120:123], v[214:217]
    v_lshl_add_u32 v237, v69, 9, v70
    s_lshl_b32 s64, s30, 3
    v_mfma_f32_16x16x32_bf16 v[152:155], v[20:23], a[124:127], v[152:155]
    s_lshl_b32 s65, s26, 1
    s_add_u32 s64, s64, s65
    v_mfma_f32_16x16x32_bf16 v[218:221], a[124:127], a[124:127], v[218:221]
    s_mul_i32 s4, s64, 80
    s_mul_i32 s65, s31, 5
    s_waitcnt vmcnt(5)
    ds_read_b128 a[144:147], v8 offset:8192
    ds_read_b128 a[148:151], v8 offset:10240
    ds_read_b128 a[152:155], v9 offset:8192
    ds_read_b128 a[156:159], v9 offset:10240
    s_waitcnt lgkmcnt(4)
    s_waitcnt lgkmcnt(0)
    s_barrier
    s_waitcnt vmcnt(0)
    s_mov_b32 s96, 0
    s_branch FW_c
FW_l:
    buffer_load_dwordx2 v[28:29], v239, s[40:43], s66 offen sc1
    s_waitcnt vmcnt(0)
FW_c:
    v_cmp_ne_u64 s[62:63], s[94:95], v[28:29]
    s_add_u32 s96, s96, 1
    s_cmp_eq_u64 s[62:63], 0
    s_cbranch_scc1 FW_d
    s_cmp_lt_u32 s96, 40000
    s_cbranch_scc1 FW_l
FW_d:
    s_add_u32 m0, s69, 0
    s_nop 0
    buffer_load_dwordx4 v2, s[40:43], s82 offen offset:0 sc1 lds
    buffer_load_dwordx4 v2, s[40:43], s82 offen offset:1024 sc1 lds
    buffer_load_dwordx4 v2, s[40:43], s82 offen offset:2048 sc1 lds
    buffer_load_dwordx4 v2, s[40:43], s82 offen offset:3072 sc1 lds
    s_add_u32 m0, s69, 4096
    s_add_u32 s82, s82, 4096
    buffer_load_dwordx4 v2, s[40:43], s82 offen offset:0 sc1 lds
    s_add_u32 m0, s69, 20480
    s_add_u32 s82, s82, 16384
    buffer_load_dwordx4 v2, s[40:43], s82 offen offset:0 sc1 lds
    buffer_load_dwordx4 v2, s[40:43], s82 offen offset:1024 sc1 lds
    buffer_load_dwordx4 v2, s[40:43], s82 offen offset:2048 sc1 lds
    buffer_load_dwordx4 v2, s[40:43], s82 offen offset:3072 sc1 lds
    s_add_u32 m0, s69, 24576
    s_add_u32 s82, s82, 4096
    buffer_load_dwordx4 v2, s[40:43], s82 offen offset:0 sc1 lds
    s_add_u32 m0, s69, 40960
    s_add_u32 s82, s82, 16384
    buffer_load_dwordx4 v2, s[40:43], s82 offen offset:0 sc1 lds
    buffer_load_dwordx4 v2, s[40:43], s82 offen offset:1024 sc1 lds
    s_cmp_lg_u32 s26, 0
    s_cbranch_scc1 FP_skip
    s_mov_b64 exec, 1
    buffer_store_dwordx2 v[24:25], v244, s[40:43], s9 offen sc1
    s_mov_b64 exec, -1
FP_skip:
    v_mfma_f32_16x16x32_bf16 v[148:151], v[20:23], a[128:131], v[148:151]
    s_add_u32 s4, s4, s65
    s_lshl_b32 s4, s4, 8
    v_mfma_f32_16x16x32_bf16 v[214:217], a[128:131], a[128:131], v[214:217]
    s_add_u32 s4, s4, 0
    s_mul_i32 s6, s64, 208
    v_mfma_f32_16x16x32_bf16 v[152:155], v[20:23], a[132:135], v[152:155]
    s_mul_i32 s65, s31, 12
    s_add_u32 s6, s6, s65
    v_mfma_f32_16x16x32_bf16 v[218:221], a[132:135], a[132:135], v[218:221]
    s_lshr_b32 s65, s31, 2
    s_mul_i32 s65, s65, 4
    v_mfma_f32_16x16x32_bf16 v[148:151], v[20:23], a[136:139], v[148:151]
    s_add_u32 s6, s6, s65
    s_lshl_b32 s6, s6, 8
    v_mfma_f32_16x16x32_bf16 v[214:217], a[136:139], a[136:139], v[214:217]
    s_add_u32 s6, s6, 5373952
    s_lshl_b32 s64, s28, 2
    v_mfma_f32_16x16x32_bf16 v[152:155], v[20:23], a[140:143], v[152:155]
    s_add_u32 s64, s64, s26
    s_mul_i32 s5, s64, 84
    v_mfma_f32_16x16x32_bf16 v[218:221], a[140:143], a[140:143], v[218:221]
    s_mul_i32 s65, s29, 10
    s_add_u32 s5, s5, s65
    v_mfma_f32_16x16x32_bf16 v[148:151], v[20:23], a[144:147], v[148:151]
    s_lshl_b32 s5, s5, 8
    s_add_u32 s5, s5, 2621440
    v_mfma_f32_16x16x32_bf16 v[214:217], a[144:147], a[144:147], v[214:217]
    s_lshl_b32 s65, s29, 7
    s_add_u32 s64, s64, s65
    v_mfma_f32_16x16x32_bf16 v[152:155], v[20:23], a[148:151], v[152:155]
    s_lshl_b32 s7, s64, 7
    s_add_u32 s7, s7, 15925248
    v_mfma_f32_16x16x32_bf16 v[218:221], a[148:151], a[148:151], v[218:221]
    v_mul_u32_u24 v68, 13108, v0
    v_lshrrev_b32 v68, 16, v68
    v_mfma_f32_16x16x32_bf16 v[148:151], v[20:23], a[152:155], v[148:151]
    v_mul_u32_u24 v69, 5, v68
    v_sub_u32 v69, v0, v69
    v_mfma_f32_16x16x32_bf16 v[214:217], a[152:155], a[152:155], v[214:217]
    v_cmp_le_u32 vcc, 21, v68
    s_nop 1
    v_cndmask_b32 v70, 0, 1, vcc
    v_mfma_f32_16x16x32_bf16 v[152:155], v[20:23], a[156:159], v[152:155]
    v_mul_u32_u24 v71, 21, v70
    v_sub_u32 v68, v68, v71
    v_mfma_f32_16x16x32_bf16 v[218:221], a[156:159], a[156:159], v[218:221]
    v_mul_u32_u24 v71, 5, v70
    v_add_u32 v69, v69, v71
    v_mul_u32_u24 v71, 20, v70
    v_add_u32 v71, v71, v68
    v_add_u32 v72, 40, v71
    v_cmp_eq_u32 vcc, 20, v68
    s_nop 1
    v_cndmask_b32 v72, v72, 32, vcc
    v_lshlrev_b32 v71, 7, v71
    v_add_u32 v71, 155648, v71
    v_lshlrev_b32 v70, 7, v70
    v_add_u32 v70, 161792, v70
    v_cndmask_b32 v71, v71, v70, vcc
    v_lshrrev_b32 v68, 2, v69
    v_and_b32 v69, 3, v69
    v_lshrrev_b32 v70, 1, v68
    v_lshl_add_u32 v71, v70, 6, v71
    v_lshl_add_u32 v71, v69, 4, v71
    v_and_b32 v70, 1, v68
    v_lshl_add_u32 v228, v70, 3, v71
    v_lshrrev_b32 v70, 4, v72
    v_add_u32 v70, -2, v70
    v_mul_u32_u24 v71, 5, v68
    v_lshrrev_b32 v71, 1, v71
    v_add_u32 v70, v70, v71
    v_lshlrev_b32 v70, 10, v70
    v_and_b32 v72, 15, v72
    v_lshl_add_u32 v72, v69, 4, v72
    v_lshl_add_u32 v226, v72, 4, v70
    v_add_u32 v226, 69632, v226
    s_waitcnt vmcnt(7)
    ds_read_b64_tr_b16 a[160:161], v222 offset:0
    ds_read_b64_tr_b16 a[162:163], v222 offset:2048
    ds_read_b64_tr_b16 a[164:165], v223 offset:0
    ds_read_b64_tr_b16 a[166:167], v223 offset:2048
    ds_read_b64_tr_b16 a[168:169], v224 offset:0
    ds_read_b64_tr_b16 a[170:171], v224 offset:2048
    ds_read_b64_tr_b16 a[172:173], v225 offset:0
    ds_read_b64_tr_b16 a[174:175], v225 offset:2048
    s_barrier
    ds_read_b128 v[36:39], v10 offset:0
    ds_read_b128 v[40:43], v10 offset:1024
    ds_read_b128 v[44:47], v10 offset:2048
    ds_read_b128 v[48:51], v10 offset:3072
    ds_read_b128 v[52:55], v10 offset:4096
    s_waitcnt lgkmcnt(2)
    v_mfma_f32_16x16x32_bf16 v[76:79], a[0:3], v[36:39], 0
    ds_read_b128 v[56:59], v10 offset:5120
    v_cndmask_b32 v214, v214, v215, s[70:71]
    v_mfma_f32_16x16x32_bf16 v[96:99], a[4:7], v[36:39], 0
    ds_read_b128 v[60:63], v10 offset:6144
    v_cndmask_b32 v218, v218, v219, s[70:71]
    v_mfma_f32_16x16x32_bf16 v[80:83], a[0:3], v[40:43], 0
    ds_read_b128 v[64:67], v10 offset:7168
    v_cndmask_b32 v214, v214, v216, s[72:73]
    v_mfma_f32_16x16x32_bf16 v[100:103], a[4:7], v[40:43], 0
    ds_read_b128 v[68:71], v10 offset:8192
    v_cndmask_b32 v218, v218, v220, s[72:73]
    v_mfma_f32_16x16x32_bf16 v[84:87], a[0:3], v[44:47], 0
    ds_read_b128 v[72:75], v10 offset:9216
    v_cndmask_b32 v214, v214, v217, s[74:75]
    v_mfma_f32_16x16x32_bf16 v[104:107], a[4:7], v[44:47], 0
    buffer_load_dwordx4 v2, s[40:43], s82 offen offset:2048 sc1 lds
    s_waitcnt lgkmcnt(5)
    v_mfma_f32_16x16x32_bf16 v[88:91], a[0:3], v[48:51], 0
    buffer_load_dwordx4 v2, s[40:43], s82 offen offset:3072 sc1 lds
    v_mfma_f32_16x16x32_bf16 v[108:111], a[4:7], v[48:51], 0
    s_add_u32 m0, s69, 45056
    s_add_u32 s82, s82, 4096
    v_mfma_f32_16x16x32_bf16 v[92:95], a[0:3], v[52:55], 0
    buffer_load_dwordx4 v2, s[40:43], s82 offen offset:0 sc1 lds
    v_mfma_f32_16x16x32_bf16 v[112:115], a[4:7], v[52:55], 0
    v_cndmask_b32 v218, v218, v221, s[74:75]
    s_waitcnt lgkmcnt(2)
    v_mfma_f32_16x16x32_bf16 v[76:79], a[8:11], v[56:59], v[76:79]
    ds_read_b128 v[36:39], v10 offset:10240
    s_add_u32 m0, s69, 61440
    v_mfma_f32_16x16x32_bf16 v[96:99], a[12:15], v[56:59], v[96:99]
    ds_read_b128 v[40:43], v10 offset:11264
    s_add_u32 s82, s82, 16384
    v_mfma_f32_16x16x32_bf16 v[80:83], a[8:11], v[60:63], v[80:83]
    ds_read_b128 v[44:47], v10 offset:12288
    v_mul_f32 v148, s93, v148
    v_mfma_f32_16x16x32_bf16 v[100:103], a[12:15], v[60:63], v[100:103]
    ds_read_b128 v[48:51], v10 offset:13312
    v_mul_f32 v152, s93, v152
    v_mfma_f32_16x16x32_bf16 v[84:87], a[8:11], v[64:67], v[84:87]
    ds_read_b128 v[52:55], v10 offset:14336
    v_mul_f32 v28, v148, v148
    v_mfma_f32_16x16x32_bf16 v[104:107], a[12:15], v[64:67], v[104:107]
    buffer_load_dwordx4 v2, s[40:43], s82 offen offset:0 sc1 lds
    s_waitcnt lgkmcnt(5)
    v_mfma_f32_16x16x32_bf16 v[88:91], a[8:11], v[68:71], v[88:91]
    buffer_load_dwordx4 v2, s[40:43], s82 offen offset:1024 sc1 lds
    v_mfma_f32_16x16x32_bf16 v[108:111], a[12:15], v[68:71], v[108:111]
    buffer_load_dwordx4 v2, s[40:43], s82 offen offset:2048 sc1 lds
    v_mfma_f32_16x16x32_bf16 v[92:95], a[8:11], v[72:75], v[92:95]
    v_mul_f32 v29, v152, v152
    v_fma_f32 v214, v214, s93, -v28
    v_mfma_f32_16x16x32_bf16 v[112:115], a[12:15], v[72:75], v[112:115]
    v_fma_f32 v218, v218, s93, -v29
    s_waitcnt lgkmcnt(2)
    v_mfma_f32_16x16x32_bf16 v[76:79], a[16:19], v[36:39], v[76:79]
    ds_read_b128 v[56:59], v10 offset:15360
    v_max_f32 v214, 0, v214
    v_mfma_f32_16x16x32_bf16 v[96:99], a[20:23], v[36:39], v[96:99]
    ds_read_b128 v[60:63], v10 offset:16384
    v_max_f32 v218, 0, v218
    v_mfma_f32_16x16x32_bf16 v[80:83], a[16:19], v[40:43], v[80:83]
    ds_read_b128 v[64:67], v10 offset:17408
    v_cvt_pk_bf16_f32 v214, v214, v214
    v_mfma_f32_16x16x32_bf16 v[100:103], a[20:23], v[40:43], v[100:103]
    ds_read_b128 v[68:71], v10 offset:18432
    v_cvt_pk_bf16_f32 v218, v218, v218
    v_mfma_f32_16x16x32_bf16 v[84:87], a[16:19], v[44:47], v[84:87]
    ds_read_b128 v[72:75], v10 offset:19456
    v_cvt_pk_bf16_f32 v148, v148, v148
    v_mfma_f32_16x16x32_bf16 v[104:107], a[20:23], v[44:47], v[104:107]
    buffer_load_dwordx4 v2, s[40:43], s82 offen offset:3072 sc1 lds
    s_waitcnt lgkmcnt(5)
    v_mfma_f32_16x16x32_bf16 v[88:91], a[16:19], v[48:51], v[88:91]
    s_add_u32 m0, s69, 65536
    s_add_u32 s82, s82, 4096
    v_mfma_f32_16x16x32_bf16 v[108:111], a[20:23], v[48:51], v[108:111]
    buffer_load_dwordx4 v2, s[40:43], s82 offen offset:0 sc1 lds
    v_mfma_f32_16x16x32_bf16 v[92:95], a[16:19], v[52:55], v[92:95]
    s_add_u32 m0, s69, 81920
    s_add_u32 s82, s82, 16384
    v_mfma_f32_16x16x32_bf16 v[112:115], a[20:23], v[52:55], v[112:115]
    buffer_load_dwordx4 v2, s[40:43], s82 offen offset:0 sc1 lds
    s_waitcnt vmcnt(11)
    s_barrier
    s_waitcnt lgkmcnt(2)
    v_mfma_f32_16x16x32_bf16 v[76:79], a[24:27], v[56:59], v[76:79]
    ds_read_b128 v[36:39], v10 offset:20480
    v_cvt_pk_bf16_f32 v152, v152, v152
    v_mfma_f32_16x16x32_bf16 v[96:99], a[28:31], v[56:59], v[96:99]
    ds_read_b128 v[40:43], v10 offset:21504
    v_and_b32 v214, 0xffff0000, v214
    v_mfma_f32_16x16x32_bf16 v[80:83], a[24:27], v[60:63], v[80:83]
    ds_read_b128 v[44:47], v10 offset:22528
    v_and_b32 v218, 0xffff0000, v218
    v_mfma_f32_16x16x32_bf16 v[100:103], a[28:31], v[60:63], v[100:103]
    ds_read_b128 v[48:51], v10 offset:23552
    v_and_b32 v148, 0xffff0000, v148
    v_mfma_f32_16x16x32_bf16 v[84:87], a[24:27], v[64:67], v[84:87]
    ds_read_b128 v[52:55], v10 offset:24576
    v_and_b32 v152, 0xffff0000, v152
    v_mfma_f32_16x16x32_bf16 v[104:107], a[28:31], v[64:67], v[104:107]
    buffer_load_dwordx4 v2, s[40:43], s82 offen offset:1024 sc1 lds
    s_waitcnt lgkmcnt(5)
    v_mfma_f32_16x16x32_bf16 v[88:91], a[24:27], v[68:71], v[88:91]
    buffer_load_dwordx4 v2, s[40:43], s82 offen offset:2048 sc1 lds
    v_mfma_f32_16x16x32_bf16 v[108:111], a[28:31], v[68:71], v[108:111]
    buffer_load_dwordx4 v2, s[40:43], s82 offen offset:3072 sc1 lds
    v_mfma_f32_16x16x32_bf16 v[92:95], a[24:27], v[72:75], v[92:95]
    v_add_f32 v214, 0x3727c5ac, v214
    v_add_f32 v218, 0x3727c5ac, v218
    v_mfma_f32_16x16x32_bf16 v[112:115], a[28:31], v[72:75], v[112:115]
    v_xor_b32 v148, 0x80000000, v148
    s_waitcnt lgkmcnt(2)
    v_mfma_f32_16x16x32_bf16 v[76:79], a[32:35], v[36:39], v[76:79]
    ds_read_b128 v[56:59], v10 offset:25600
    s_add_u32 m0, s69, 86016
    v_mfma_f32_16x16x32_bf16 v[96:99], a[36:39], v[36:39], v[96:99]
    ds_read_b128 v[60:63], v10 offset:26624
    s_add_u32 s82, s82, 4096
    v_mfma_f32_16x16x32_bf16 v[80:83], a[32:35], v[40:43], v[80:83]
    ds_read_b128 v[64:67], v10 offset:27648
    v_xor_b32 v152, 0x80000000, v152
    v_mfma_f32_16x16x32_bf16 v[100:103], a[36:39], v[40:43], v[100:103]
    ds_read_b128 v[68:71], v10 offset:28672
    v_cvt_pk_bf16_f32 v214, v214, v214
    v_mfma_f32_16x16x32_bf16 v[84:87], a[32:35], v[44:47], v[84:87]
    ds_read_b128 v[72:75], v10 offset:29696
    v_cvt_pk_bf16_f32 v218, v218, v218
    v_mfma_f32_16x16x32_bf16 v[104:107], a[36:39], v[44:47], v[104:107]
    buffer_load_dwordx4 v2, s[40:43], s82 offen offset:0 sc1 lds
    s_waitcnt lgkmcnt(5)
    v_mfma_f32_16x16x32_bf16 v[88:91], a[32:35], v[48:51], v[88:91]
    buffer_load_dwordx4 v[116:119], v2, s[40:43], s67 offen offset:0 sc1
    v_mfma_f32_16x16x32_bf16 v[108:111], a[36:39], v[48:51], v[108:111]
    buffer_load_dwordx4 v[120:123], v2, s[40:43], s67 offen offset:1024 sc1
    v_mfma_f32_16x16x32_bf16 v[92:95], a[32:35], v[52:55], v[92:95]
    v_and_b32 v214, 0xffff0000, v214
    v_and_b32 v218, 0xffff0000, v218
    v_mfma_f32_16x16x32_bf16 v[112:115], a[36:39], v[52:55], v[112:115]
    v_sqrt_f32 v214, v214
    s_waitcnt lgkmcnt(2)
    v_mfma_f32_16x16x32_bf16 v[76:79], a[40:43], v[56:59], v[76:79]
    ds_read_b128 v[36:39], v10 offset:30720
    v_sqrt_f32 v218, v218
    v_mfma_f32_16x16x32_bf16 v[96:99], a[44:47], v[56:59], v[96:99]
    ds_read_b128 v[40:43], v10 offset:31744
    v_cvt_pk_bf16_f32 v214, v214, v214
    v_mfma_f32_16x16x32_bf16 v[80:83], a[40:43], v[60:63], v[80:83]
    ds_read_b128 v[44:47], v10 offset:32768
    v_cvt_pk_bf16_f32 v218, v218, v218
    v_mfma_f32_16x16x32_bf16 v[100:103], a[44:47], v[60:63], v[100:103]
    ds_read_b128 v[48:51], v10 offset:33792
    v_and_b32 v214, 0xffff0000, v214
    v_mfma_f32_16x16x32_bf16 v[84:87], a[40:43], v[64:67], v[84:87]
    ds_read_b128 v[52:55], v10 offset:34816
    v_and_b32 v218, 0xffff0000, v218
    v_mfma_f32_16x16x32_bf16 v[104:107], a[44:47], v[64:67], v[104:107]
    v_rcp_f32 v214, v214
    s_waitcnt lgkmcnt(5)
    v_mfma_f32_16x16x32_bf16 v[88:91], a[40:43], v[68:71], v[88:91]
    v_rcp_f32 v218, v218
    v_mfma_f32_16x16x32_bf16 v[108:111], a[44:47], v[68:71], v[108:111]
    s_mov_b64 exec, s[60:61]
    ds_write_b32 v16, v214 offset:0
    ds_write_b32 v16, v148 offset:512
    ds_write_b32 v16, v218 offset:64
    ds_write_b32 v16, v152 offset:576
    s_mov_b64 exec, -1
    v_mfma_f32_16x16x32_bf16 v[92:95], a[40:43], v[72:75], v[92:95]
    s_waitcnt lgkmcnt(0)
    ds_read_b128 v[164:167], v17 offset:512
    v_mfma_f32_16x16x32_bf16 v[112:115], a[44:47], v[72:75], v[112:115]
    ds_read_b128 v[156:159], v17 offset:0
    v_mfma_f32_16x16x32_bf16 v[76:79], a[48:51], v[36:39], v[76:79]
    ds_read_b128 v[56:59], v10 offset:35840
    v_mfma_f32_16x16x32_bf16 v[96:99], a[52:55], v[36:39], v[96:99]
    ds_read_b128 v[60:63], v10 offset:36864
    v_mfma_f32_16x16x32_bf16 v[80:83], a[48:51], v[40:43], v[80:83]
    ds_read_b128 v[64:67], v10 offset:37888
    v_mfma_f32_16x16x32_bf16 v[100:103], a[52:55], v[40:43], v[100:103]
    ds_read_b128 v[68:71], v10 offset:38912
    v_mfma_f32_16x16x32_bf16 v[84:87], a[48:51], v[44:47], v[84:87]
    ds_read_b128 v[72:75], v10 offset:39936
    v_mfma_f32_16x16x32_bf16 v[104:107], a[52:55], v[44:47], v[104:107]
    ds_read_b32 v190, v16 offset:0
    v_mfma_f32_16x16x32_bf16 v[88:91], a[48:51], v[48:51], v[88:91]
    ds_read_b32 v194, v16 offset:512
    v_mfma_f32_16x16x32_bf16 v[108:111], a[52:55], v[48:51], v[108:111]
    ds_read_b128 v[168:171], v17 offset:576
    v_mfma_f32_16x16x32_bf16 v[92:95], a[48:51], v[52:55], v[92:95]
    ds_read_b128 v[160:163], v17 offset:64
    v_mfma_f32_16x16x32_bf16 v[112:115], a[52:55], v[52:55], v[112:115]
    ds_read_b32 v192, v16 offset:64
    s_waitcnt vmcnt(12)
    s_barrier
    s_waitcnt lgkmcnt(7)
    v_mfma_f32_16x16x32_bf16 v[76:79], a[56:59], v[56:59], v[76:79]
    ds_read_b128 v[36:39], v10 offset:40960
    s_add_u32 m0, s69, 102400
    v_mfma_f32_16x16x32_bf16 v[96:99], a[60:63], v[56:59], v[96:99]
    ds_read_b128 v[40:43], v10 offset:41984
    s_add_u32 s82, s82, 16384
    v_mfma_f32_16x16x32_bf16 v[80:83], a[56:59], v[60:63], v[80:83]
    ds_read_b128 v[44:47], v10 offset:43008
    v_mfma_f32_16x16x32_bf16 v[100:103], a[60:63], v[60:63], v[100:103]
    ds_read_b128 v[48:51], v10 offset:44032
    v_mfma_f32_16x16x32_bf16 v[84:87], a[56:59], v[64:67], v[84:87]
    ds_read_b128 v[52:55], v10 offset:45056
    v_mfma_f32_16x16x32_bf16 v[104:107], a[60:63], v[64:67], v[104:107]
    buffer_load_dwordx4 v2, s[40:43], s82 offen offset:0 sc1 lds
    s_waitcnt lgkmcnt(10)
    v_mfma_f32_16x16x32_bf16 v[88:91], a[56:59], v[68:71], v[88:91]
    buffer_load_dwordx4 v2, s[40:43], s82 offen offset:1024 sc1 lds
    v_mfma_f32_16x16x32_bf16 v[108:111], a[60:63], v[68:71], v[108:111]
    ds_read_b32 v196, v16 offset:576
    s_waitcnt lgkmcnt(0)
    v_mfma_f32_16x16x32_bf16 v[92:95], a[56:59], v[72:75], v[92:95]
    v_mul_f32 v172, s78, v156
    v_mul_f32 v173, s78, v157
    v_mfma_f32_16x16x32_bf16 v[112:115], a[60:63], v[72:75], v[112:115]
    v_mul_f32 v174, s78, v158
    v_mfma_f32_16x16x32_bf16 v[76:79], a[64:67], v[36:39], v[76:79]
    ds_read_b128 v[56:59], v10 offset:46080
    v_mul_f32 v175, s78, v159
    v_mfma_f32_16x16x32_bf16 v[96:99], a[68:71], v[36:39], v[96:99]
    ds_read_b128 v[60:63], v10 offset:47104
    v_mul_f32 v176, s78, v160
    v_mfma_f32_16x16x32_bf16 v[80:83], a[64:67], v[40:43], v[80:83]
    ds_read_b128 v[64:67], v10 offset:48128
    v_mul_f32 v177, s78, v161
    v_mfma_f32_16x16x32_bf16 v[100:103], a[68:71], v[40:43], v[100:103]
    ds_read_b128 v[68:71], v10 offset:49152
    v_mul_f32 v178, s78, v162
    v_mfma_f32_16x16x32_bf16 v[84:87], a[64:67], v[44:47], v[84:87]
    ds_read_b128 v[72:75], v10 offset:50176
    v_mul_f32 v179, s78, v163
    v_mfma_f32_16x16x32_bf16 v[104:107], a[68:71], v[44:47], v[104:107]
    buffer_load_dwordx4 v2, s[40:43], s82 offen offset:2048 sc1 lds
    v_mfma_f32_16x16x32_bf16 v[88:91], a[64:67], v[48:51], v[88:91]
    buffer_load_dwordx4 v2, s[40:43], s82 offen offset:3072 sc1 lds
    v_mfma_f32_16x16x32_bf16 v[108:111], a[68:71], v[48:51], v[108:111]
    v_mul_f32 v198, s78, v190
    v_mul_f32 v200, s78, v192
    v_mfma_f32_16x16x32_bf16 v[92:95], a[64:67], v[52:55], v[92:95]
    s_waitcnt vmcnt(4)
    v_add_f32 v116, v116, v120
    v_mfma_f32_16x16x32_bf16 v[112:115], a[68:71], v[52:55], v[112:115]
    v_add_f32 v117, v117, v121
    s_waitcnt lgkmcnt(2)
    v_mfma_f32_16x16x32_bf16 v[76:79], a[72:75], v[56:59], v[76:79]
    ds_read_b128 v[36:39], v11 offset:0
    s_add_u32 m0, s69, 106496
    v_mfma_f32_16x16x32_bf16 v[96:99], a[76:79], v[56:59], v[96:99]
    ds_read_b128 v[40:43], v11 offset:1024
    s_add_u32 s82, s82, 4096
    v_mfma_f32_16x16x32_bf16 v[80:83], a[72:75], v[60:63], v[80:83]
    ds_read_b128 v[44:47], v11 offset:2048
    v_add_f32 v118, v118, v122
    v_mfma_f32_16x16x32_bf16 v[100:103], a[76:79], v[60:63], v[100:103]
    ds_read_b128 v[48:51], v11 offset:3072
    v_add_f32 v119, v119, v123
    v_mfma_f32_16x16x32_bf16 v[84:87], a[72:75], v[64:67], v[84:87]
    ds_read_b128 v[52:55], v11 offset:4096
    v_mov_b32 v120, v116
    v_mfma_f32_16x16x32_bf16 v[104:107], a[76:79], v[64:67], v[104:107]
    buffer_load_dwordx4 v2, s[40:43], s82 offen offset:0 sc1 lds
    s_waitcnt lgkmcnt(5)
    v_mfma_f32_16x16x32_bf16 v[88:91], a[72:75], v[68:71], v[88:91]
    s_add_u32 m0, s69, 122880
    s_add_u32 s82, s82, 16384
    v_mfma_f32_16x16x32_bf16 v[108:111], a[76:79], v[68:71], v[108:111]
    buffer_load_dwordx4 v2, s[40:43], s82 offen offset:0 sc1 lds
    v_mfma_f32_16x16x32_bf16 v[92:95], a[72:75], v[72:75], v[92:95]
    v_mov_b32 v121, v117
    v_mov_b32 v122, v118
    v_mfma_f32_16x16x32_bf16 v[112:115], a[76:79], v[72:75], v[112:115]
    v_mov_b32 v123, v119
    s_waitcnt lgkmcnt(2)
    v_mfma_f32_16x16x32_bf16 v[76:79], a[80:83], v[36:39], v[76:79]
    ds_read_b128 v[56:59], v11 offset:5120
    v_permlane32_swap_b32 v120, v116
    v_mfma_f32_16x16x32_bf16 v[96:99], a[84:87], v[36:39], v[96:99]
    ds_read_b128 v[60:63], v11 offset:6144
    v_permlane32_swap_b32 v121, v117
    v_mfma_f32_16x16x32_bf16 v[80:83], a[80:83], v[40:43], v[80:83]
    ds_read_b128 v[64:67], v11 offset:7168
    v_permlane32_swap_b32 v122, v118
    v_mfma_f32_16x16x32_bf16 v[100:103], a[84:87], v[40:43], v[100:103]
    ds_read_b128 v[68:71], v11 offset:8192
    v_permlane32_swap_b32 v123, v119
    v_mfma_f32_16x16x32_bf16 v[84:87], a[80:83], v[44:47], v[84:87]
    ds_read_b128 v[72:75], v11 offset:9216
    v_add_f32 v116, v116, v120
    v_mfma_f32_16x16x32_bf16 v[104:107], a[84:87], v[44:47], v[104:107]
    buffer_load_dwordx4 v2, s[40:43], s82 offen offset:1024 sc1 lds
    s_waitcnt lgkmcnt(5)
    v_mfma_f32_16x16x32_bf16 v[88:91], a[80:83], v[48:51], v[88:91]
    buffer_load_dwordx4 v2, s[40:43], s82 offen offset:2048 sc1 lds
    v_mfma_f32_16x16x32_bf16 v[108:111], a[84:87], v[48:51], v[108:111]
    v_add_f32 v117, v117, v121
    v_add_f32 v118, v118, v122
    v_mfma_f32_16x16x32_bf16 v[92:95], a[80:83], v[52:55], v[92:95]
    v_add_f32 v119, v119, v123
    v_mfma_f32_16x16x32_bf16 v[112:115], a[84:87], v[52:55], v[112:115]
    ds_write_b128 v30, v[116:119]
    s_barrier
    s_waitcnt lgkmcnt(3)
    v_mfma_f32_16x16x32_bf16 v[76:79], a[88:91], v[56:59], v[76:79]
    ds_read_b128 v[36:39], v11 offset:10240
    s_lshl_b32 s56, s29, 2
    v_mfma_f32_16x16x32_bf16 v[96:99], a[92:95], v[56:59], v[96:99]
    ds_read_b128 v[40:43], v11 offset:11264
    s_add_u32 s56, s56, s26
    v_mfma_f32_16x16x32_bf16 v[80:83], a[88:91], v[60:63], v[80:83]
    ds_read_b128 v[44:47], v11 offset:12288
    s_mul_i32 s57, s56, 62464
    v_mfma_f32_16x16x32_bf16 v[100:103], a[92:95], v[60:63], v[100:103]
    ds_read_b128 v[48:51], v11 offset:13312
    s_add_u32 s57, s57, 13008896
    v_mfma_f32_16x16x32_bf16 v[84:87], a[88:91], v[64:67], v[84:87]
    ds_read_b128 v[52:55], v11 offset:14336
    s_mul_i32 s56, s56, 25600
    v_mfma_f32_16x16x32_bf16 v[104:107], a[92:95], v[64:67], v[104:107]
    buffer_load_dwordx4 v2, s[40:43], s82 offen offset:3072 sc1 lds
    s_waitcnt lgkmcnt(6)
    v_mfma_f32_16x16x32_bf16 v[88:91], a[88:91], v[68:71], v[88:91]
    s_add_u32 m0, s69, 126976
    s_add_u32 s82, s82, 4096
    v_mfma_f32_16x16x32_bf16 v[108:111], a[92:95], v[68:71], v[108:111]
    buffer_load_dwordx4 v2, s[40:43], s82 offen offset:0 sc1 lds
    v_mfma_f32_16x16x32_bf16 v[92:95], a[88:91], v[72:75], v[92:95]
    s_add_u32 s56, s56, 12189696
    s_mul_i32 s80, s31, 192
    v_mfma_f32_16x16x32_bf16 v[112:115], a[92:95], v[72:75], v[112:115]
    s_mul_i32 s81, s26, 98304
    s_waitcnt lgkmcnt(2)
    v_mfma_f32_16x16x32_bf16 v[76:79], a[96:99], v[36:39], v[76:79]
    ds_read_b128 v[56:59], v11 offset:15360
    s_add_u32 s80, s80, s81
    v_mfma_f32_16x16x32_bf16 v[96:99], a[100:103], v[36:39], v[96:99]
    ds_read_b128 v[60:63], v11 offset:16384
    s_mul_i32 s81, s26, 6144
    v_mfma_f32_16x16x32_bf16 v[80:83], a[96:99], v[40:43], v[80:83]
    ds_read_b128 v[64:67], v11 offset:17408
    s_lshl_b32 s64, s26, 13
    v_mfma_f32_16x16x32_bf16 v[100:103], a[100:103], v[40:43], v[100:103]
    ds_read_b128 v[68:71], v11 offset:18432
    s_add_u32 s64, s64, 69632
    v_mfma_f32_16x16x32_bf16 v[84:87], a[96:99], v[44:47], v[84:87]
    ds_read_b128 v[72:75], v11 offset:19456
    v_add_u32 v33, s64, v2
    v_mfma_f32_16x16x32_bf16 v[104:107], a[100:103], v[44:47], v[104:107]
    v_and_b32 v34, 15, v1
    s_waitcnt lgkmcnt(5)
    v_mfma_f32_16x16x32_bf16 v[88:91], a[96:99], v[48:51], v[88:91]
    v_cmp_gt_u32 s[58:59], 8, v34
    s_mov_b32 s36, s12
    v_mfma_f32_16x16x32_bf16 v[108:111], a[100:103], v[48:51], v[108:111]
    s_and_b32 s37, s13, 0xffff
    s_mov_b32 s38, 1966080
    v_mfma_f32_16x16x32_bf16 v[92:95], a[96:99], v[52:55], v[92:95]
    s_mov_b32 s39, 0x00020000
    v_add_u32 v26, 0, v1
    v_mfma_f32_16x16x32_bf16 v[112:115], a[100:103], v[52:55], v[112:115]
    v_mul_u32_u24 v27, 5462, v26
    s_waitcnt lgkmcnt(2)
    v_mfma_f32_16x16x32_bf16 v[76:79], a[104:107], v[56:59], v[76:79]
    ds_read_b128 v[36:39], v11 offset:20480
    v_lshrrev_b32 v27, 16, v27
    v_mfma_f32_16x16x32_bf16 v[96:99], a[108:111], v[56:59], v[96:99]
    ds_read_b128 v[40:43], v11 offset:21504
    v_mul_u32_u24 v28, 12, v27
    v_mfma_f32_16x16x32_bf16 v[80:83], a[104:107], v[60:63], v[80:83]
    ds_read_b128 v[44:47], v11 offset:22528
    v_sub_u32 v26, v26, v28
    v_mfma_f32_16x16x32_bf16 v[100:103], a[108:111], v[60:63], v[100:103]
    ds_read_b128 v[48:51], v11 offset:23552
    v_bfe_u32 v28, v27, 2, 1
    v_mfma_f32_16x16x32_bf16 v[84:87], a[104:107], v[64:67], v[84:87]
    ds_read_b128 v[52:55], v11 offset:24576
    v_lshlrev_b32 v28, 1, v28
    v_mfma_f32_16x16x32_bf16 v[104:107], a[108:111], v[64:67], v[104:107]
    s_cmp_ge_u32 s26, 2
    s_cbranch_scc1 B7_skip
    s_add_u32 m0, s69, 143360
    s_add_u32 s82, s82, 16384
    buffer_load_dwordx4 v2, s[40:43], s82 offen offset:0 sc1 lds
    buffer_load_dwordx4 v2, s[40:43], s82 offen offset:1024 sc1 lds
    buffer_load_dwordx4 v2, s[40:43], s82 offen offset:2048 sc1 lds
    buffer_load_dwordx4 v2, s[40:43], s82 offen offset:3072 sc1 lds
    s_add_u32 m0, s69, 147456
    s_add_u32 s82, s82, 4096
    buffer_load_dwordx4 v2, s[40:43], s82 offen offset:0 sc1 lds
B7_skip:
    s_waitcnt lgkmcnt(5)
    v_mfma_f32_16x16x32_bf16 v[88:91], a[104:107], v[68:71], v[88:91]
    v_xor_b32 v26, v26, v28
    v_and_b32 v28, 12, v27
    v_mfma_f32_16x16x32_bf16 v[108:111], a[108:111], v[68:71], v[108:111]
    v_add_u32 v27, v27, v28
    v_mul_u32_u24 v27, 3072, v27
    v_mfma_f32_16x16x32_bf16 v[92:95], a[104:107], v[72:75], v[92:95]
    v_lshl_add_u32 v214, v26, 4, v27
    v_add_u32 v217, 12288, v214
    v_mfma_f32_16x16x32_bf16 v[112:115], a[108:111], v[72:75], v[112:115]
    v_add_u32 v26, 64, v1
    s_waitcnt lgkmcnt(2)
    v_mfma_f32_16x16x32_bf16 v[76:79], a[112:115], v[36:39], v[76:79]
    ds_read_b128 v[56:59], v11 offset:25600
    v_mul_u32_u24 v27, 5462, v26
    v_mfma_f32_16x16x32_bf16 v[96:99], a[116:119], v[36:39], v[96:99]
    ds_read_b128 v[60:63], v11 offset:26624
    v_lshrrev_b32 v27, 16, v27
    v_mfma_f32_16x16x32_bf16 v[80:83], a[112:115], v[40:43], v[80:83]
    ds_read_b128 v[64:67], v11 offset:27648
    v_mul_u32_u24 v28, 12, v27
    v_mfma_f32_16x16x32_bf16 v[100:103], a[116:119], v[40:43], v[100:103]
    ds_read_b128 v[68:71], v11 offset:28672
    v_sub_u32 v26, v26, v28
    v_mfma_f32_16x16x32_bf16 v[84:87], a[112:115], v[44:47], v[84:87]
    ds_read_b128 v[72:75], v11 offset:29696
    v_bfe_u32 v28, v27, 2, 1
    v_mfma_f32_16x16x32_bf16 v[104:107], a[116:119], v[44:47], v[104:107]
    buffer_store_dwordx4 a[160:163], v2, s[40:43], s16 offen sc1
    s_waitcnt lgkmcnt(5)
    v_mfma_f32_16x16x32_bf16 v[88:91], a[112:115], v[48:51], v[88:91]
    v_lshlrev_b32 v28, 1, v28
    v_xor_b32 v26, v26, v28
    v_mfma_f32_16x16x32_bf16 v[108:111], a[116:119], v[48:51], v[108:111]
    v_and_b32 v28, 12, v27
    v_add_u32 v27, v27, v28
    v_mfma_f32_16x16x32_bf16 v[92:95], a[112:115], v[52:55], v[92:95]
    v_mul_u32_u24 v27, 3072, v27
    v_lshl_add_u32 v215, v26, 4, v27
    v_mfma_f32_16x16x32_bf16 v[112:115], a[116:119], v[52:55], v[112:115]
    v_add_u32 v218, 12288, v215
    s_barrier
    s_waitcnt lgkmcnt(2)
    v_mfma_f32_16x16x32_bf16 v[76:79], a[120:123], v[56:59], v[76:79]
    ds_read_b128 v[36:39], v11 offset:30720
    v_mfma_f32_16x16x32_bf16 v[96:99], a[124:127], v[56:59], v[96:99]
    ds_read_b128 v[40:43], v11 offset:31744
    v_mfma_f32_16x16x32_bf16 v[80:83], a[120:123], v[60:63], v[80:83]
    ds_read_b128 v[44:47], v11 offset:32768
    v_mfma_f32_16x16x32_bf16 v[100:103], a[124:127], v[60:63], v[100:103]
    ds_read_b128 v[48:51], v11 offset:33792
    v_mfma_f32_16x16x32_bf16 v[84:87], a[120:123], v[64:67], v[84:87]
    ds_read_b128 v[52:55], v11 offset:34816
    v_mfma_f32_16x16x32_bf16 v[104:107], a[124:127], v[64:67], v[104:107]
    buffer_store_dwordx4 a[164:167], v2, s[40:43], s17 offen sc1
    s_waitcnt lgkmcnt(5)
    v_mfma_f32_16x16x32_bf16 v[88:91], a[120:123], v[68:71], v[88:91]
    ds_read_b32 v180, v31 offset:0
    ds_read_b32 v182, v31 offset:64
    v_mfma_f32_16x16x32_bf16 v[108:111], a[124:127], v[68:71], v[108:111]
    ds_read_b32 v184, v31 offset:128
    ds_read_b32 v186, v31 offset:192
    v_mfma_f32_16x16x32_bf16 v[92:95], a[120:123], v[72:75], v[92:95]
    ds_read_b32 v188, v31 offset:256
    ds_read_b32 v116, v31 offset:512
    v_mfma_f32_16x16x32_bf16 v[112:115], a[124:127], v[72:75], v[112:115]
    ds_read_b32 v117, v31 offset:576
    s_waitcnt lgkmcnt(9)
    v_mfma_f32_16x16x32_bf16 v[76:79], a[128:131], v[36:39], v[76:79]
    ds_read_b128 v[56:59], v11 offset:35840
    v_mfma_f32_16x16x32_bf16 v[96:99], a[132:135], v[36:39], v[96:99]
    ds_read_b128 v[60:63], v11 offset:36864
    v_mfma_f32_16x16x32_bf16 v[80:83], a[128:131], v[40:43], v[80:83]
    ds_read_b128 v[64:67], v11 offset:37888
    v_mfma_f32_16x16x32_bf16 v[100:103], a[132:135], v[40:43], v[100:103]
    ds_read_b128 v[68:71], v11 offset:38912
    v_mfma_f32_16x16x32_bf16 v[84:87], a[128:131], v[44:47], v[84:87]
    ds_read_b128 v[72:75], v11 offset:39936
    v_mfma_f32_16x16x32_bf16 v[104:107], a[132:135], v[44:47], v[104:107]
    buffer_store_dwordx4 a[168:171], v2, s[40:43], s89 offen sc1
    s_waitcnt lgkmcnt(12)
    v_mfma_f32_16x16x32_bf16 v[88:91], a[128:131], v[48:51], v[88:91]
    ds_read_b32 v118, v31 offset:640
    ds_read_b32 v119, v31 offset:704
    v_mfma_f32_16x16x32_bf16 v[108:111], a[132:135], v[48:51], v[108:111]
    ds_read_b32 v120, v31 offset:768
    ds_read_b32 v121, v31 offset:1024
    v_mfma_f32_16x16x32_bf16 v[92:95], a[128:131], v[52:55], v[92:95]
    ds_read_b32 v122, v31 offset:1088
    ds_read_b32 v123, v31 offset:1152
    v_mfma_f32_16x16x32_bf16 v[112:115], a[132:135], v[52:55], v[112:115]
    ds_read_b32 v124, v31 offset:1216
    s_waitcnt lgkmcnt(9)
    v_mfma_f32_16x16x32_bf16 v[76:79], a[136:139], v[56:59], v[76:79]
    ds_read_b128 v[36:39], v11 offset:40960
    v_mfma_f32_16x16x32_bf16 v[96:99], a[140:143], v[56:59], v[96:99]
    ds_read_b128 v[40:43], v11 offset:41984
    v_mfma_f32_16x16x32_bf16 v[80:83], a[136:139], v[60:63], v[80:83]
    ds_read_b128 v[44:47], v11 offset:43008
    v_mfma_f32_16x16x32_bf16 v[100:103], a[140:143], v[60:63], v[100:103]
    ds_read_b128 v[48:51], v11 offset:44032
    v_mfma_f32_16x16x32_bf16 v[84:87], a[136:139], v[64:67], v[84:87]
    ds_read_b128 v[52:55], v11 offset:45056
    v_mfma_f32_16x16x32_bf16 v[104:107], a[140:143], v[64:67], v[104:107]
    buffer_store_dwordx4 a[172:175], v2, s[40:43], s91 offen sc1
    s_waitcnt lgkmcnt(12)
    v_mfma_f32_16x16x32_bf16 v[88:91], a[136:139], v[68:71], v[88:91]
    ds_read_b32 v125, v31 offset:1280
    ds_read_b32 v126, v31 offset:1536
    v_mfma_f32_16x16x32_bf16 v[108:111], a[140:143], v[68:71], v[108:111]
    ds_read_b32 v127, v31 offset:1600
    ds_read_b32 v128, v31 offset:1664
    v_mfma_f32_16x16x32_bf16 v[92:95], a[136:139], v[72:75], v[92:95]
    ds_read_b32 v129, v31 offset:1728
    ds_read_b32 v130, v31 offset:1792
    v_mfma_f32_16x16x32_bf16 v[112:115], a[140:143], v[72:75], v[112:115]
    s_waitcnt lgkmcnt(0)
    v_mfma_f32_16x16x32_bf16 v[76:79], a[144:147], v[36:39], v[76:79]
    ds_read_b128 v[56:59], v11 offset:46080
    v_add_f32 v180, v180, v116
    v_mfma_f32_16x16x32_bf16 v[96:99], a[148:151], v[36:39], v[96:99]
    ds_read_b128 v[60:63], v11 offset:47104
    v_add_f32 v121, v121, v126
    v_mfma_f32_16x16x32_bf16 v[80:83], a[144:147], v[40:43], v[80:83]
    ds_read_b128 v[64:67], v11 offset:48128
    v_add_f32 v182, v182, v117
    v_mfma_f32_16x16x32_bf16 v[100:103], a[148:151], v[40:43], v[100:103]
    ds_read_b128 v[68:71], v11 offset:49152
    v_add_f32 v122, v122, v127
    v_mfma_f32_16x16x32_bf16 v[84:87], a[144:147], v[44:47], v[84:87]
    ds_read_b128 v[72:75], v11 offset:50176
    v_add_f32 v184, v184, v118
    v_mfma_f32_16x16x32_bf16 v[104:107], a[148:151], v[44:47], v[104:107]
    buffer_load_dwordx2 v[230:231], v232, s[40:43], s53 offen sc1
    v_mfma_f32_16x16x32_bf16 v[88:91], a[144:147], v[48:51], v[88:91]
    buffer_load_dwordx2 v[24:25], v239, s[40:43], s52 offen sc1
    v_mfma_f32_16x16x32_bf16 v[108:111], a[148:151], v[48:51], v[108:111]
    v_add_f32 v123, v123, v128
    v_add_f32 v186, v186, v119
    v_mfma_f32_16x16x32_bf16 v[92:95], a[144:147], v[52:55], v[92:95]
    v_add_f32 v124, v124, v129
    v_add_f32 v188, v188, v120
    v_mfma_f32_16x16x32_bf16 v[112:115], a[148:151], v[52:55], v[112:115]
    v_add_f32 v125, v125, v130
    s_waitcnt lgkmcnt(2)
    v_mfma_f32_16x16x32_bf16 v[76:79], a[152:155], v[56:59], v[76:79]
    v_add_f32 v180, v180, v121
    v_add_f32 v182, v182, v122
    v_mfma_f32_16x16x32_bf16 v[96:99], a[156:159], v[56:59], v[96:99]
    v_add_f32 v184, v184, v123
    v_add_f32 v186, v186, v124
    v_mfma_f32_16x16x32_bf16 v[80:83], a[152:155], v[60:63], v[80:83]
    v_add_f32 v188, v188, v125
    v_add_u32 v26, 128, v1
    v_mfma_f32_16x16x32_bf16 v[100:103], a[156:159], v[60:63], v[100:103]
    v_mul_u32_u24 v27, 5462, v26
    v_lshrrev_b32 v27, 16, v27
    v_mfma_f32_16x16x32_bf16 v[84:87], a[152:155], v[64:67], v[84:87]
    v_mul_u32_u24 v28, 12, v27
    v_sub_u32 v26, v26, v28
    v_mfma_f32_16x16x32_bf16 v[104:107], a[156:159], v[64:67], v[104:107]
    v_bfe_u32 v28, v27, 2, 1
    s_waitcnt lgkmcnt(0)
    v_mfma_f32_16x16x32_bf16 v[88:91], a[152:155], v[68:71], v[88:91]
    v_lshlrev_b32 v28, 1, v28
    v_xor_b32 v26, v26, v28
    v_mfma_f32_16x16x32_bf16 v[108:111], a[156:159], v[68:71], v[108:111]
    v_and_b32 v28, 12, v27
    v_add_u32 v27, v27, v28
    v_mfma_f32_16x16x32_bf16 v[92:95], a[152:155], v[72:75], v[92:95]
    v_mul_u32_u24 v27, 3072, v27
    v_lshl_add_u32 v216, v26, 4, v27
    v_mfma_f32_16x16x32_bf16 v[112:115], a[156:159], v[72:75], v[112:115]
    v_add_u32 v219, 12288, v216
    v_pk_fma_f32 v[84:85], v[164:165], v[184:185], v[84:85] op_sel_hi:[1,0,1]
    v_pk_fma_f32 v[86:87], v[166:167], v[184:185], v[86:87] op_sel_hi:[1,0,1]
    s_add_u32 m0, s81, 0
    s_nop 0
    buffer_load_dwordx4 v214, s[36:39], s80 offen lds
    v_pk_fma_f32 v[104:105], v[168:169], v[184:185], v[104:105] op_sel_hi:[1,0,1]
    v_pk_fma_f32 v[106:107], v[170:171], v[184:185], v[106:107] op_sel_hi:[1,0,1]
    s_add_u32 m0, s81, 1024
    s_nop 0
    buffer_load_dwordx4 v215, s[36:39], s80 offen lds
    v_pk_mul_f32 v[60:61], v[84:85], v[156:157]
    v_pk_mul_f32 v[62:63], v[86:87], v[158:159]
    s_add_u32 m0, s81, 2048
    s_nop 0
    buffer_load_dwordx4 v216, s[36:39], s80 offen lds
    v_pk_mul_f32 v[64:65], v[104:105], v[160:161]
    v_pk_mul_f32 v[66:67], v[106:107], v[162:163]
    s_add_u32 m0, s81, 3072
    s_nop 0
    buffer_load_dwordx4 v217, s[36:39], s80 offen lds
    v_cvt_pk_bf16_f32 v48, v60, v61
    v_cvt_pk_bf16_f32 v49, v62, v63
    s_add_u32 m0, s81, 4096
    s_nop 0
    buffer_load_dwordx4 v218, s[36:39], s80 offen lds
    v_cvt_pk_bf16_f32 v50, v64, v65
    v_cvt_pk_bf16_f32 v51, v66, v67
    s_add_u32 m0, s81, 5120
    s_nop 0
    buffer_load_dwordx4 v219, s[36:39], s80 offen lds
    v_pk_mul_f32 v[68:69], v[84:85], v[172:173]
    v_pk_fma_f32 v[84:85], v[84:85], v[156:157], s[76:77]
    s_add_u32 m0, s81, 24576
    s_add_u32 s80, s80, 393216
    buffer_load_dwordx4 v214, s[36:39], s80 offen lds
    v_exp_f32 v68, v68 clamp
    v_exp_f32 v69, v69 clamp
    s_add_u32 m0, s81, 25600
    s_nop 0
    buffer_load_dwordx4 v215, s[36:39], s80 offen lds
    v_max_f32 v84, s79, v84
    v_max_f32 v85, s79, v85
    s_add_u32 m0, s81, 26624
    s_nop 0
    buffer_load_dwordx4 v216, s[36:39], s80 offen lds
    v_pk_add_f32 v[84:85], v[84:85], v[68:69]
    v_pk_mul_f32 v[70:71], v[86:87], v[174:175]
    s_add_u32 m0, s81, 27648
    s_nop 0
    buffer_load_dwordx4 v217, s[36:39], s80 offen lds
    v_pk_fma_f32 v[86:87], v[86:87], v[158:159], s[76:77]
    v_exp_f32 v70, v70 clamp
    s_add_u32 m0, s81, 28672
    s_nop 0
    buffer_load_dwordx4 v218, s[36:39], s80 offen lds
    v_exp_f32 v71, v71 clamp
    v_max_f32 v86, s79, v86
    s_add_u32 m0, s81, 29696
    s_nop 0
    buffer_load_dwordx4 v219, s[36:39], s80 offen lds
    v_max_f32 v87, s79, v87
    v_pk_add_f32 v[86:87], v[86:87], v[70:71]
    v_pk_mul_f32 v[72:73], v[104:105], v[176:177]
    v_pk_fma_f32 v[104:105], v[104:105], v[160:161], s[76:77]
    v_exp_f32 v72, v72 clamp
    v_exp_f32 v73, v73 clamp
    v_max_f32 v104, s79, v104
    v_max_f32 v105, s79, v105
    v_pk_add_f32 v[104:105], v[104:105], v[72:73]
    v_pk_mul_f32 v[74:75], v[106:107], v[178:179]
    v_pk_fma_f32 v[106:107], v[106:107], v[162:163], s[76:77]
    v_exp_f32 v74, v74 clamp
    v_exp_f32 v75, v75 clamp
    v_max_f32 v106, s79, v106
    v_max_f32 v107, s79, v107
    v_pk_add_f32 v[106:107], v[106:107], v[74:75]
    v_cvt_pk_bf16_f32 v44, v84, v85
    v_cvt_pk_bf16_f32 v45, v86, v87
    v_cvt_pk_bf16_f32 v46, v104, v105
    v_cvt_pk_bf16_f32 v47, v106, v107
    v_cndmask_b32 v48, v48, v20, s[58:59]
    v_cndmask_b32 v49, v49, v20, s[58:59]
    v_cndmask_b32 v50, v50, v20, s[58:59]
    v_cndmask_b32 v51, v51, v20, s[58:59]
    v_pk_fma_f32 v[88:89], v[164:165], v[186:187], v[88:89] op_sel_hi:[1,0,1]
    v_pk_fma_f32 v[90:91], v[166:167], v[186:187], v[90:91] op_sel_hi:[1,0,1]
    v_pk_fma_f32 v[108:109], v[168:169], v[186:187], v[108:109] op_sel_hi:[1,0,1]
    v_pk_fma_f32 v[110:111], v[170:171], v[186:187], v[110:111] op_sel_hi:[1,0,1]
    v_pk_mul_f32 v[60:61], v[88:89], v[156:157]
    v_pk_mul_f32 v[62:63], v[90:91], v[158:159]
    v_pk_mul_f32 v[64:65], v[108:109], v[160:161]
    v_pk_mul_f32 v[66:67], v[110:111], v[162:163]
    v_cvt_pk_bf16_f32 v52, v60, v61
    v_cvt_pk_bf16_f32 v53, v62, v63
    v_cvt_pk_bf16_f32 v54, v64, v65
    v_cvt_pk_bf16_f32 v55, v66, v67
    v_pk_fma_f32 v[92:93], v[164:165], v[188:189], v[92:93] op_sel_hi:[1,0,1]
    v_pk_fma_f32 v[94:95], v[166:167], v[188:189], v[94:95] op_sel_hi:[1,0,1]
    v_pk_fma_f32 v[112:113], v[168:169], v[188:189], v[112:113] op_sel_hi:[1,0,1]
    v_pk_fma_f32 v[114:115], v[170:171], v[188:189], v[114:115] op_sel_hi:[1,0,1]
    v_pk_mul_f32 v[60:61], v[92:93], v[156:157]
    v_pk_mul_f32 v[62:63], v[94:95], v[158:159]
    v_pk_mul_f32 v[64:65], v[112:113], v[160:161]
    v_pk_mul_f32 v[66:67], v[114:115], v[162:163]
    v_cvt_pk_bf16_f32 v56, v60, v61
    v_cvt_pk_bf16_f32 v57, v62, v63
    v_cvt_pk_bf16_f32 v58, v64, v65
    v_cvt_pk_bf16_f32 v59, v66, v67
    v_pk_fma_f32 v[76:77], v[164:165], v[180:181], v[76:77] op_sel_hi:[1,0,1]
    v_pk_fma_f32 v[78:79], v[166:167], v[180:181], v[78:79] op_sel_hi:[1,0,1]
    v_pk_fma_f32 v[96:97], v[168:169], v[180:181], v[96:97] op_sel_hi:[1,0,1]
    v_pk_fma_f32 v[98:99], v[170:171], v[180:181], v[98:99] op_sel_hi:[1,0,1]
    v_pk_mul_f32 v[68:69], v[76:77], v[172:173]
    v_pk_fma_f32 v[76:77], v[76:77], v[156:157], s[76:77]
    v_exp_f32 v68, v68 clamp
    v_exp_f32 v69, v69 clamp
    v_max_f32 v76, s79, v76
    v_max_f32 v77, s79, v77
    v_pk_add_f32 v[76:77], v[76:77], v[68:69]
    v_pk_mul_f32 v[70:71], v[78:79], v[174:175]
    v_pk_fma_f32 v[78:79], v[78:79], v[158:159], s[76:77]
    v_exp_f32 v70, v70 clamp
    v_exp_f32 v71, v71 clamp
    v_max_f32 v78, s79, v78
    v_max_f32 v79, s79, v79
    v_pk_add_f32 v[78:79], v[78:79], v[70:71]
    v_pk_mul_f32 v[72:73], v[96:97], v[176:177]
    v_pk_fma_f32 v[96:97], v[96:97], v[160:161], s[76:77]
    v_exp_f32 v72, v72 clamp
    v_exp_f32 v73, v73 clamp
    v_max_f32 v96, s79, v96
    v_max_f32 v97, s79, v97
    v_pk_add_f32 v[96:97], v[96:97], v[72:73]
    v_pk_mul_f32 v[74:75], v[98:99], v[178:179]
    v_pk_fma_f32 v[98:99], v[98:99], v[162:163], s[76:77]
    v_exp_f32 v74, v74 clamp
    v_exp_f32 v75, v75 clamp
    v_max_f32 v98, s79, v98
    v_max_f32 v99, s79, v99
    v_pk_add_f32 v[98:99], v[98:99], v[74:75]
    v_cvt_pk_bf16_f32 v36, v76, v77
    v_cvt_pk_bf16_f32 v37, v78, v79
    v_cvt_pk_bf16_f32 v38, v96, v97
    v_cvt_pk_bf16_f32 v39, v98, v99
    v_pk_fma_f32 v[80:81], v[164:165], v[182:183], v[80:81] op_sel_hi:[1,0,1]
    v_pk_fma_f32 v[82:83], v[166:167], v[182:183], v[82:83] op_sel_hi:[1,0,1]
    v_pk_fma_f32 v[100:101], v[168:169], v[182:183], v[100:101] op_sel_hi:[1,0,1]
    v_pk_fma_f32 v[102:103], v[170:171], v[182:183], v[102:103] op_sel_hi:[1,0,1]
    v_pk_mul_f32 v[68:69], v[80:81], v[172:173]
    v_pk_fma_f32 v[80:81], v[80:81], v[156:157], s[76:77]
    v_exp_f32 v68, v68 clamp
    v_exp_f32 v69, v69 clamp
    v_max_f32 v80, s79, v80
    v_max_f32 v81, s79, v81
    v_pk_add_f32 v[80:81], v[80:81], v[68:69]
    v_pk_mul_f32 v[70:71], v[82:83], v[174:175]
    v_pk_fma_f32 v[82:83], v[82:83], v[158:159], s[76:77]
    v_exp_f32 v70, v70 clamp
    v_exp_f32 v71, v71 clamp
    v_max_f32 v82, s79, v82
    v_max_f32 v83, s79, v83
    v_pk_add_f32 v[82:83], v[82:83], v[70:71]
    v_pk_mul_f32 v[72:73], v[100:101], v[176:177]
    v_pk_fma_f32 v[100:101], v[100:101], v[160:161], s[76:77]
    v_exp_f32 v72, v72 clamp
    v_exp_f32 v73, v73 clamp
    v_max_f32 v100, s79, v100
    v_max_f32 v101, s79, v101
    v_pk_add_f32 v[100:101], v[100:101], v[72:73]
    v_pk_mul_f32 v[74:75], v[102:103], v[178:179]
    v_pk_fma_f32 v[102:103], v[102:103], v[162:163], s[76:77]
    v_exp_f32 v74, v74 clamp
    v_exp_f32 v75, v75 clamp
    v_max_f32 v102, s79, v102
    v_max_f32 v103, s79, v103
    v_pk_add_f32 v[102:103], v[102:103], v[74:75]
    v_cvt_pk_bf16_f32 v40, v80, v81
    v_cvt_pk_bf16_f32 v41, v82, v83
    v_cvt_pk_bf16_f32 v42, v100, v101
    v_cvt_pk_bf16_f32 v43, v102, v103
    v_mfma_f32_16x16x32_bf16 v[96:99], v[44:47], v[48:51], 0
    v_mfma_f32_16x16x32_bf16 v[100:103], v[44:47], v[52:55], 0
    v_mfma_f32_16x16x32_bf16 v[104:107], v[44:47], v[56:59], 0
    v_mfma_f32_16x16x32_bf16 v[76:79], v[36:39], v[48:51], 0
    v_mfma_f32_16x16x32_bf16 v[80:83], v[36:39], v[52:55], 0
    v_mfma_f32_16x16x32_bf16 v[84:87], v[40:43], v[48:51], 0
    v_mfma_f32_16x16x32_bf16 v[88:91], v[40:43], v[52:55], 0
    v_mfma_f32_16x16x32_bf16 v[92:95], v[40:43], v[56:59], 0
    s_waitcnt vmcnt(12)
    s_mov_b32 s96, 0
    ds_write_b128 v33, v[96:99] offset:5120
    ds_write_b128 v33, v[100:103] offset:6144
    ds_write_b128 v33, v[104:107] offset:7168
    ds_write_b128 v33, v[76:79] offset:0
    ds_write_b128 v33, v[80:83] offset:1024
    ds_write_b128 v33, v[84:87] offset:2048
    ds_write_b128 v33, v[88:91] offset:3072
    ds_write_b128 v33, v[92:95] offset:4096
FP_l:
    v_lshrrev_b32 v26, 4, v231
    v_lshrrev_b32 v27, 4, v25
    v_xor_b32 v26, s95, v26
    v_xor_b32 v27, s95, v27
    v_xor_b32 v28, s94, v230
    v_xor_b32 v29, s94, v24
    v_or3_b32 v26, v26, v27, v28
    v_or_b32 v26, v26, v29
    v_cmp_ne_u32 vcc, 0, v26
    s_add_u32 s96, s96, 1
    s_cbranch_vccz FP_d
    buffer_load_dwordx2 v[230:231], v232, s[40:43], s53 offen sc1
    buffer_load_dwordx2 v[24:25], v239, s[40:43], s52 offen sc1
    s_waitcnt vmcnt(0)
    s_cmp_lt_u32 s96, 40000
    s_cbranch_scc1 FP_l
FP_d:
    v_cmp_ne_u32 vcc, s92, v25
    s_lshl_b32 s97, s2, 3
    s_add_u32 s97, s97, 16066560
    s_waitcnt lgkmcnt(0)
    s_barrier
    ds_read_b128 v[76:79], v226 offset:0
    ds_read_b128 v[80:83], v226 offset:8192
    ds_read_b128 v[84:87], v226 offset:16384
    ds_read_b128 v[88:91], v226 offset:24576
    ds_read_b128 v[36:39], v12 offset:0
    ds_read_b128 v[40:43], v12 offset:1024
    ds_read_b128 v[44:47], v13 offset:0
    s_cmp_eq_u64 vcc, 0
    s_cselect_b32 s84, 1, 0
    s_mov_b32 s61, -2
    s_waitcnt lgkmcnt(3)
    v_pk_add_f32 v[76:77], v[76:77], v[80:81]
    v_pk_add_f32 v[84:85], v[84:85], v[88:89]
    v_pk_add_f32 v[78:79], v[78:79], v[82:83]
    v_pk_add_f32 v[86:87], v[86:87], v[90:91]
    v_pk_add_f32 v[76:77], v[76:77], v[84:85]
    v_pk_add_f32 v[78:79], v[78:79], v[86:87]
    v_min_u32 v76, s61, v76
    v_min_u32 v77, s61, v77
    v_min_u32 v78, s61, v78
    v_min_u32 v79, s61, v79
    s_mov_b64 exec, s[10:11]
    buffer_store_dwordx4 v[76:79], v227, s[40:43], s8 offen sc1
    s_mov_b64 exec, -1
    s_cmp_lg_u32 s26, 0
    s_cbranch_scc1 nf_3
    s_mov_b64 exec, 1
    buffer_store_dwordx2 v[242:243], v244, s[40:43], s97 offen sc1
    s_mov_b64 exec, -1
nf_3:
    s_mov_b32 s53, 16066560
    s_waitcnt lgkmcnt(0)
    v_mfma_f32_16x16x32_bf16 v[116:119], v[36:39], a[0:3], 0
    ds_read_b128 v[56:59], v12 offset:2048
    s_lshl_b32 s62, s28, 6
    v_mfma_f32_16x16x32_bf16 v[128:131], v[36:39], a[4:7], 0
    ds_read_b128 v[60:63], v12 offset:3072
    s_mul_i32 s62, s62, 1280
    v_mfma_f32_16x16x32_bf16 v[120:123], v[40:43], a[0:3], 0
    ds_read_b128 v[64:67], v13 offset:128
    s_mul_i32 s64, s29, 160
    v_mfma_f32_16x16x32_bf16 v[132:135], v[40:43], a[4:7], 0
    buffer_load_dwordx4 a[160:163], v2, s[40:43], s56 offen offset:0 sc1
    v_mfma_f32_16x16x32_bf16 v[124:127], v[44:47], a[0:3], 0
    buffer_load_dwordx4 a[164:167], v2, s[40:43], s56 offen offset:1024 sc1
    v_mfma_f32_16x16x32_bf16 v[136:139], v[44:47], a[4:7], 0
    s_add_u32 s58, s62, s64
    s_waitcnt lgkmcnt(0)
    v_mfma_f32_16x16x32_bf16 v[116:119], v[56:59], a[8:11], v[116:119]
    ds_read_b128 v[36:39], v12 offset:5120
    v_add_u32 v26, 0, v0
    v_mfma_f32_16x16x32_bf16 v[128:131], v[56:59], a[12:15], v[128:131]
    ds_read_b128 v[40:43], v12 offset:6144
    v_mul_u32_u24 v27, 6554, v26
    v_mfma_f32_16x16x32_bf16 v[120:123], v[60:63], a[8:11], v[120:123]
    ds_read_b128 v[44:47], v13 offset:5120
    v_lshrrev_b32 v27, 16, v27
    v_mfma_f32_16x16x32_bf16 v[132:135], v[60:63], a[12:15], v[132:135]
    buffer_load_dwordx4 a[168:171], v2, s[40:43], s56 offen offset:2048 sc1
    v_mfma_f32_16x16x32_bf16 v[124:127], v[64:67], a[8:11], v[124:127]
    v_mul_u32_u24 v233, 1120, v27
    v_lshl_add_u32 v233, v26, 4, v233
    v_mfma_f32_16x16x32_bf16 v[136:139], v[64:67], a[12:15], v[136:139]
    v_add_u32 v26, 256, v0
    s_barrier
    s_waitcnt lgkmcnt(0)
    v_mfma_f32_16x16x32_bf16 v[116:119], v[36:39], a[16:19], v[116:119]
    ds_read_b128 v[56:59], v12 offset:7168
    v_mul_u32_u24 v27, 6554, v26
    v_mfma_f32_16x16x32_bf16 v[128:131], v[36:39], a[20:23], v[128:131]
    ds_read_b128 v[60:63], v12 offset:8192
    v_lshrrev_b32 v27, 16, v27
    v_mfma_f32_16x16x32_bf16 v[120:123], v[40:43], a[16:19], v[120:123]
    ds_read_b128 v[64:67], v13 offset:5248
    v_mul_u32_u24 v234, 1120, v27
    v_mfma_f32_16x16x32_bf16 v[132:135], v[40:43], a[20:23], v[132:135]
    buffer_load_dwordx4 a[172:175], v2, s[40:43], s56 offen offset:3072 sc1
    v_mfma_f32_16x16x32_bf16 v[124:127], v[44:47], a[16:19], v[124:127]
    s_add_u32 s56, s56, 4096
    v_lshl_add_u32 v234, v26, 4, v234
    v_mfma_f32_16x16x32_bf16 v[136:139], v[44:47], a[20:23], v[136:139]
    buffer_load_dwordx4 a[176:179], v2, s[40:43], s56 offen offset:0 sc1
    s_waitcnt lgkmcnt(0)
    v_mfma_f32_16x16x32_bf16 v[116:119], v[56:59], a[24:27], v[116:119]
    ds_read_b128 v[36:39], v12 offset:10240
    v_add_u32 v26, 512, v0
    v_mfma_f32_16x16x32_bf16 v[128:131], v[56:59], a[28:31], v[128:131]
    ds_read_b128 v[40:43], v12 offset:11264
    v_mul_u32_u24 v27, 6554, v26
    v_mfma_f32_16x16x32_bf16 v[120:123], v[60:63], a[24:27], v[120:123]
    ds_read_b128 v[44:47], v13 offset:10240
    v_lshrrev_b32 v27, 16, v27
    v_mfma_f32_16x16x32_bf16 v[132:135], v[60:63], a[28:31], v[132:135]
    buffer_load_dwordx4 a[180:183], v2, s[40:43], s56 offen offset:1024 sc1
    v_mfma_f32_16x16x32_bf16 v[124:127], v[64:67], a[24:27], v[124:127]
    s_add_u32 m0, s81, 49152
    s_add_u32 s80, s80, 393216
    v_mfma_f32_16x16x32_bf16 v[136:139], v[64:67], a[28:31], v[136:139]
    buffer_load_dwordx4 v214, s[36:39], s80 offen lds
    s_waitcnt lgkmcnt(0)
    v_mfma_f32_16x16x32_bf16 v[116:119], v[36:39], a[32:35], v[116:119]
    ds_read_b128 v[56:59], v12 offset:12288
    v_mul_u32_u24 v235, 1120, v27
    v_mfma_f32_16x16x32_bf16 v[128:131], v[36:39], a[36:39], v[128:131]
    ds_read_b128 v[60:63], v12 offset:13312
    v_lshl_add_u32 v235, v26, 4, v235
    v_mfma_f32_16x16x32_bf16 v[120:123], v[40:43], a[32:35], v[120:123]
    ds_read_b128 v[64:67], v13 offset:10368
    v_mfma_f32_16x16x32_bf16 v[132:135], v[40:43], a[36:39], v[132:135]
    buffer_load_dwordx4 a[184:187], v2, s[40:43], s56 offen offset:2048 sc1
    v_mfma_f32_16x16x32_bf16 v[124:127], v[44:47], a[32:35], v[124:127]
    buffer_load_dwordx4 a[188:191], v2, s[40:43], s56 offen offset:3072 sc1
    v_mfma_f32_16x16x32_bf16 v[136:139], v[44:47], a[36:39], v[136:139]
    s_add_u32 s56, s56, 4096
    s_waitcnt lgkmcnt(0)
    v_mfma_f32_16x16x32_bf16 v[116:119], v[56:59], a[40:43], v[116:119]
    ds_read_b128 v[36:39], v12 offset:15360
    v_mfma_f32_16x16x32_bf16 v[128:131], v[56:59], a[44:47], v[128:131]
    ds_read_b128 v[40:43], v12 offset:16384
    v_mfma_f32_16x16x32_bf16 v[120:123], v[60:63], a[40:43], v[120:123]
    ds_read_b128 v[44:47], v13 offset:15360
    v_mfma_f32_16x16x32_bf16 v[132:135], v[60:63], a[44:47], v[132:135]
    buffer_load_dwordx4 a[192:195], v2, s[40:43], s56 offen offset:0 sc1
    v_mfma_f32_16x16x32_bf16 v[124:127], v[64:67], a[40:43], v[124:127]
    s_add_u32 m0, s81, 50176
    s_nop 0
    v_mfma_f32_16x16x32_bf16 v[136:139], v[64:67], a[44:47], v[136:139]
    buffer_load_dwordx4 v215, s[36:39], s80 offen lds
    s_waitcnt lgkmcnt(0)
    v_mfma_f32_16x16x32_bf16 v[116:119], v[36:39], a[48:51], v[116:119]
    ds_read_b128 v[56:59], v12 offset:17408
    v_mfma_f32_16x16x32_bf16 v[128:131], v[36:39], a[52:55], v[128:131]
    ds_read_b128 v[60:63], v12 offset:18432
    v_mfma_f32_16x16x32_bf16 v[120:123], v[40:43], a[48:51], v[120:123]
    ds_read_b128 v[64:67], v13 offset:15488
    v_mfma_f32_16x16x32_bf16 v[132:135], v[40:43], a[52:55], v[132:135]
    buffer_load_dwordx4 a[196:199], v2, s[40:43], s56 offen offset:1024 sc1
    v_mfma_f32_16x16x32_bf16 v[124:127], v[44:47], a[48:51], v[124:127]
    buffer_load_dwordx4 a[200:203], v2, s[40:43], s56 offen offset:2048 sc1
    v_mfma_f32_16x16x32_bf16 v[136:139], v[44:47], a[52:55], v[136:139]
    s_cmp_ge_u32 s26, 2
    s_cselect_b32 s59, 0x7fffffff, s58
    s_waitcnt lgkmcnt(0)
    v_mfma_f32_16x16x32_bf16 v[116:119], v[56:59], a[56:59], v[116:119]
    ds_read_b128 v[36:39], v12 offset:20480
    s_add_u32 s60, s83, 139264
    v_mfma_f32_16x16x32_bf16 v[128:131], v[56:59], a[60:63], v[128:131]
    ds_read_b128 v[40:43], v12 offset:21504
    v_and_b32 v26, 15, v1
    v_mfma_f32_16x16x32_bf16 v[120:123], v[60:63], a[56:59], v[120:123]
    ds_read_b128 v[44:47], v13 offset:20480
    v_lshrrev_b32 v27, 4, v1
    v_mfma_f32_16x16x32_bf16 v[132:135], v[60:63], a[60:63], v[132:135]
    buffer_load_dwordx4 a[204:207], v2, s[40:43], s56 offen offset:3072 sc1
    v_mfma_f32_16x16x32_bf16 v[124:127], v[64:67], a[56:59], v[124:127]
    s_add_u32 s56, s56, 4096
    s_add_u32 m0, s81, 51200
    v_mfma_f32_16x16x32_bf16 v[136:139], v[64:67], a[60:63], v[136:139]
    s_nop 0
    s_waitcnt lgkmcnt(0)
    v_mfma_f32_16x16x32_bf16 v[116:119], v[36:39], a[64:67], v[116:119]
    ds_read_b128 v[56:59], v12 offset:22528
    v_lshlrev_b32 v27, 4, v27
    v_mfma_f32_16x16x32_bf16 v[128:131], v[36:39], a[68:71], v[128:131]
    ds_read_b128 v[60:63], v12 offset:23552
    v_lshl_add_u32 v16, v26, 7, v27
    v_mfma_f32_16x16x32_bf16 v[120:123], v[40:43], a[64:67], v[120:123]
    ds_read_b128 v[64:67], v13 offset:20608
    v_add_u32 v16, 155648, v16
    v_mfma_f32_16x16x32_bf16 v[132:135], v[40:43], a[68:71], v[132:135]
    buffer_load_dwordx4 v216, s[36:39], s80 offen lds
    v_mfma_f32_16x16x32_bf16 v[124:127], v[44:47], a[64:67], v[124:127]
    buffer_load_dwordx4 a[208:211], v2, s[40:43], s56 offen offset:0 sc1
    v_mfma_f32_16x16x32_bf16 v[136:139], v[44:47], a[68:71], v[136:139]
    buffer_load_dwordx4 a[212:215], v2, s[40:43], s56 offen offset:1024 sc1
    s_waitcnt lgkmcnt(0)
    v_mfma_f32_16x16x32_bf16 v[116:119], v[56:59], a[72:75], v[116:119]
    ds_read_b128 v[36:39], v12 offset:25600
    v_add_u32 v17, 161792, v27
    v_mfma_f32_16x16x32_bf16 v[128:131], v[56:59], a[76:79], v[128:131]
    ds_read_b128 v[40:43], v12 offset:26624
    v_cmp_le_u32 vcc, 4, v26
    v_mfma_f32_16x16x32_bf16 v[120:123], v[60:63], a[72:75], v[120:123]
    ds_read_b128 v[44:47], v13 offset:25600
    v_add_u32 v19, 128, v17
    v_mfma_f32_16x16x32_bf16 v[132:135], v[60:63], a[76:79], v[132:135]
    buffer_load_dwordx4 a[216:219], v2, s[40:43], s56 offen offset:2048 sc1
    v_mfma_f32_16x16x32_bf16 v[124:127], v[64:67], a[72:75], v[124:127]
    s_add_u32 m0, s81, 52224
    s_nop 0
    v_mfma_f32_16x16x32_bf16 v[136:139], v[64:67], a[76:79], v[136:139]
    buffer_load_dwordx4 v217, s[36:39], s80 offen lds
    s_waitcnt lgkmcnt(0)
    v_mfma_f32_16x16x32_bf16 v[116:119], v[36:39], a[80:83], v[116:119]
    ds_read_b128 v[56:59], v12 offset:27648
    v_cndmask_b32 v18, v17, v19, vcc
    v_mfma_f32_16x16x32_bf16 v[128:131], v[36:39], a[84:87], v[128:131]
    ds_read_b128 v[60:63], v12 offset:28672
    v_mfma_f32_16x16x32_bf16 v[120:123], v[40:43], a[80:83], v[120:123]
    ds_read_b128 v[64:67], v13 offset:25728
    v_mfma_f32_16x16x32_bf16 v[132:135], v[40:43], a[84:87], v[132:135]
    buffer_load_dwordx4 a[220:223], v2, s[40:43], s56 offen offset:3072 sc1
    v_mfma_f32_16x16x32_bf16 v[124:127], v[44:47], a[80:83], v[124:127]
    s_add_u32 s56, s56, 4096
    ds_read_b128 v[202:205], v32 offset:0
    v_mfma_f32_16x16x32_bf16 v[136:139], v[44:47], a[84:87], v[136:139]
    buffer_load_dwordx4 a[224:227], v2, s[40:43], s56 offen offset:0 sc1
    s_waitcnt lgkmcnt(1)
    v_mfma_f32_16x16x32_bf16 v[116:119], v[56:59], a[88:91], v[116:119]
    ds_read_b128 v[36:39], v12 offset:30720
    v_mfma_f32_16x16x32_bf16 v[128:131], v[56:59], a[92:95], v[128:131]
    ds_read_b128 v[40:43], v12 offset:31744
    v_mfma_f32_16x16x32_bf16 v[120:123], v[60:63], a[88:91], v[120:123]
    ds_read_b128 v[44:47], v13 offset:30720
    v_mfma_f32_16x16x32_bf16 v[132:135], v[60:63], a[92:95], v[132:135]
    buffer_load_dwordx4 a[228:231], v2, s[40:43], s56 offen offset:1024 sc1
    v_mfma_f32_16x16x32_bf16 v[124:127], v[64:67], a[88:91], v[124:127]
    s_add_u32 m0, s81, 53248
    s_nop 0
    v_mfma_f32_16x16x32_bf16 v[136:139], v[64:67], a[92:95], v[136:139]
    buffer_load_dwordx4 v218, s[36:39], s80 offen lds
    s_waitcnt lgkmcnt(0)
    v_mfma_f32_16x16x32_bf16 v[116:119], v[36:39], a[96:99], v[116:119]
    ds_read_b128 v[56:59], v12 offset:32768
    v_mfma_f32_16x16x32_bf16 v[128:131], v[36:39], a[100:103], v[128:131]
    ds_read_b128 v[60:63], v12 offset:33792
    v_mfma_f32_16x16x32_bf16 v[120:123], v[40:43], a[96:99], v[120:123]
    ds_read_b128 v[64:67], v13 offset:30848
    v_mfma_f32_16x16x32_bf16 v[132:135], v[40:43], a[100:103], v[132:135]
    buffer_load_dwordx4 a[232:235], v2, s[40:43], s56 offen offset:2048 sc1
    v_mfma_f32_16x16x32_bf16 v[124:127], v[44:47], a[96:99], v[124:127]
    buffer_load_dwordx4 a[236:239], v2, s[40:43], s56 offen offset:3072 sc1
    v_mfma_f32_16x16x32_bf16 v[136:139], v[44:47], a[100:103], v[136:139]
    s_add_u32 s56, s56, 4096
    s_waitcnt lgkmcnt(0)
    v_mfma_f32_16x16x32_bf16 v[116:119], v[56:59], a[104:107], v[116:119]
    ds_read_b128 v[36:39], v12 offset:35840
    v_mfma_f32_16x16x32_bf16 v[128:131], v[56:59], a[108:111], v[128:131]
    ds_read_b128 v[40:43], v12 offset:36864
    v_mfma_f32_16x16x32_bf16 v[120:123], v[60:63], a[104:107], v[120:123]
    ds_read_b128 v[44:47], v13 offset:35840
    v_mfma_f32_16x16x32_bf16 v[132:135], v[60:63], a[108:111], v[132:135]
    buffer_load_dwordx4 a[240:243], v2, s[40:43], s56 offen offset:0 sc1
    v_mfma_f32_16x16x32_bf16 v[124:127], v[64:67], a[104:107], v[124:127]
    s_add_u32 m0, s81, 54272
    s_nop 0
    v_mfma_f32_16x16x32_bf16 v[136:139], v[64:67], a[108:111], v[136:139]
    buffer_load_dwordx4 v219, s[36:39], s80 offen lds
    s_waitcnt lgkmcnt(0)
    v_mfma_f32_16x16x32_bf16 v[116:119], v[36:39], a[112:115], v[116:119]
    ds_read_b128 v[56:59], v12 offset:37888
    v_mfma_f32_16x16x32_bf16 v[128:131], v[36:39], a[116:119], v[128:131]
    ds_read_b128 v[60:63], v12 offset:38912
    v_mfma_f32_16x16x32_bf16 v[120:123], v[40:43], a[112:115], v[120:123]
    ds_read_b128 v[64:67], v13 offset:35968
    v_mfma_f32_16x16x32_bf16 v[132:135], v[40:43], a[116:119], v[132:135]
    buffer_load_dwordx4 a[244:247], v2, s[40:43], s56 offen offset:1024 sc1
    v_mfma_f32_16x16x32_bf16 v[124:127], v[44:47], a[112:115], v[124:127]
    buffer_load_dwordx4 a[248:251], v2, s[40:43], s56 offen offset:2048 sc1
    v_mfma_f32_16x16x32_bf16 v[136:139], v[44:47], a[116:119], v[136:139]
    ds_read_b128 v[206:209], v32 offset:64
    s_waitcnt lgkmcnt(1)
    v_mfma_f32_16x16x32_bf16 v[116:119], v[56:59], a[120:123], v[116:119]
    ds_read_b128 v[36:39], v12 offset:40960
    v_mfma_f32_16x16x32_bf16 v[128:131], v[56:59], a[124:127], v[128:131]
    ds_read_b128 v[40:43], v12 offset:41984
    v_mfma_f32_16x16x32_bf16 v[120:123], v[60:63], a[120:123], v[120:123]
    ds_read_b128 v[44:47], v13 offset:40960
    v_mfma_f32_16x16x32_bf16 v[132:135], v[60:63], a[124:127], v[132:135]
    buffer_load_dwordx4 a[252:255], v2, s[40:43], s56 offen offset:3072 sc1
    v_mfma_f32_16x16x32_bf16 v[124:127], v[64:67], a[120:123], v[124:127]
    s_add_u32 s56, s56, 4096
    ds_read_b128 v[210:213], v32 offset:128
    v_mfma_f32_16x16x32_bf16 v[136:139], v[64:67], a[124:127], v[136:139]
    ds_read_b128 v[80:83], v32 offset:512
    s_waitcnt lgkmcnt(2)
    v_mfma_f32_16x16x32_bf16 v[116:119], v[36:39], a[128:131], v[116:119]
    ds_read_b128 v[56:59], v12 offset:43008
    v_mfma_f32_16x16x32_bf16 v[128:131], v[36:39], a[132:135], v[128:131]
    ds_read_b128 v[60:63], v12 offset:44032
    v_mfma_f32_16x16x32_bf16 v[120:123], v[40:43], a[128:131], v[120:123]
    ds_read_b128 v[64:67], v13 offset:41088
    v_mfma_f32_16x16x32_bf16 v[132:135], v[40:43], a[132:135], v[132:135]
    ds_read_b128 v[84:87], v32 offset:576
    v_mfma_f32_16x16x32_bf16 v[124:127], v[44:47], a[128:131], v[124:127]
    ds_read_b128 v[88:91], v32 offset:640
    v_mfma_f32_16x16x32_bf16 v[136:139], v[44:47], a[132:135], v[136:139]
    ds_read_b128 v[92:95], v32 offset:1024
    s_waitcnt lgkmcnt(3)
    v_mfma_f32_16x16x32_bf16 v[116:119], v[56:59], a[136:139], v[116:119]
    ds_read_b128 v[36:39], v12 offset:46080
    v_mfma_f32_16x16x32_bf16 v[128:131], v[56:59], a[140:143], v[128:131]
    ds_read_b128 v[40:43], v12 offset:47104
    v_mfma_f32_16x16x32_bf16 v[120:123], v[60:63], a[136:139], v[120:123]
    ds_read_b128 v[44:47], v13 offset:46080
    v_mfma_f32_16x16x32_bf16 v[132:135], v[60:63], a[140:143], v[132:135]
    ds_read_b128 v[96:99], v32 offset:1088
    v_mfma_f32_16x16x32_bf16 v[124:127], v[64:67], a[136:139], v[124:127]
    ds_read_b128 v[100:103], v32 offset:1152
    v_mfma_f32_16x16x32_bf16 v[136:139], v[64:67], a[140:143], v[136:139]
    ds_read_b128 v[104:107], v32 offset:1536
    s_waitcnt lgkmcnt(3)
    v_mfma_f32_16x16x32_bf16 v[116:119], v[36:39], a[144:147], v[116:119]
    ds_read_b128 v[56:59], v12 offset:48128
    v_mfma_f32_16x16x32_bf16 v[128:131], v[36:39], a[148:151], v[128:131]
    ds_read_b128 v[60:63], v12 offset:49152
    v_mfma_f32_16x16x32_bf16 v[120:123], v[40:43], a[144:147], v[120:123]
    ds_read_b128 v[64:67], v13 offset:46208
    v_mfma_f32_16x16x32_bf16 v[132:135], v[40:43], a[148:151], v[132:135]
    ds_read_b128 v[108:111], v32 offset:1600
    v_mfma_f32_16x16x32_bf16 v[124:127], v[44:47], a[144:147], v[124:127]
    ds_read_b128 v[112:115], v32 offset:1664
    s_waitcnt lgkmcnt(0)
    v_mfma_f32_16x16x32_bf16 v[136:139], v[44:47], a[148:151], v[136:139]
    v_add_f32 v202, v202, v80
    v_mfma_f32_16x16x32_bf16 v[116:119], v[56:59], a[152:155], v[116:119]
    v_add_f32 v203, v203, v81
    v_add_f32 v92, v92, v104
    v_mfma_f32_16x16x32_bf16 v[128:131], v[56:59], a[156:159], v[128:131]
    v_add_f32 v93, v93, v105
    v_add_f32 v204, v204, v82
    v_mfma_f32_16x16x32_bf16 v[120:123], v[60:63], a[152:155], v[120:123]
    v_add_f32 v205, v205, v83
    v_add_f32 v94, v94, v106
    v_mfma_f32_16x16x32_bf16 v[132:135], v[60:63], a[156:159], v[132:135]
    v_add_f32 v95, v95, v107
    v_add_f32 v206, v206, v84
    v_mfma_f32_16x16x32_bf16 v[124:127], v[64:67], a[152:155], v[124:127]
    v_add_f32 v207, v207, v85
    v_add_f32 v96, v96, v108
    v_mfma_f32_16x16x32_bf16 v[136:139], v[64:67], a[156:159], v[136:139]
    v_add_f32 v97, v97, v109
    v_add_f32 v208, v208, v86
    v_add_f32 v209, v209, v87
    v_add_f32 v98, v98, v110
    v_add_f32 v99, v99, v111
    v_add_f32 v210, v210, v88
    v_add_f32 v211, v211, v89
    v_add_f32 v100, v100, v112
    v_add_f32 v101, v101, v113
    v_add_f32 v212, v212, v90
    v_add_f32 v213, v213, v91
    v_add_f32 v102, v102, v114
    v_add_f32 v103, v103, v115
    v_add_f32 v202, v202, v92
    v_add_f32 v203, v203, v93
    v_add_f32 v204, v204, v94
    v_add_f32 v205, v205, v95
    v_add_f32 v206, v206, v96
    v_add_f32 v207, v207, v97
    v_add_f32 v208, v208, v98
    v_add_f32 v209, v209, v99
    v_add_f32 v210, v210, v100
    v_add_f32 v211, v211, v101
    v_add_f32 v212, v212, v102
    v_add_f32 v213, v213, v103
    buffer_load_dwordx2 v[230:231], v232, s[40:43], s53 offen sc1
    s_mov_b64 exec, s[10:11]
    s_mov_b32 s64, 0
    buffer_load_dwordx4 v[76:79], v227, s[40:43], s64 offen offset:0 sc1
    s_mov_b32 s64, 0
    buffer_load_dwordx4 v[80:83], v227, s[40:43], s64 offen offset:3584 sc1
    s_mov_b32 s64, 4096
    buffer_load_dwordx4 v[84:87], v227, s[40:43], s64 offen offset:3072 sc1
    s_mov_b32 s64, 8192
    buffer_load_dwordx4 v[88:91], v227, s[40:43], s64 offen offset:2560 sc1
    s_mov_b32 s64, 12288
    buffer_load_dwordx4 v[92:95], v227, s[40:43], s64 offen offset:2048 sc1
    s_mov_b32 s64, 16384
    buffer_load_dwordx4 v[96:99], v227, s[40:43], s64 offen offset:1536 sc1
    s_mov_b32 s64, 20480
    buffer_load_dwordx4 v[100:103], v227, s[40:43], s64 offen offset:1024 sc1
    s_mov_b32 s64, 24576
    buffer_load_dwordx4 v[104:107], v227, s[40:43], s64 offen offset:512 sc1
    s_mov_b32 s64, 28672
    buffer_load_dwordx4 v[108:111], v227, s[40:43], s64 offen offset:0 sc1
    s_mov_b32 s64, 28672
    buffer_load_dwordx4 v[112:115], v227, s[40:43], s64 offen offset:3584 sc1
    s_mov_b32 s64, 32768
    buffer_load_dwordx4 v[156:159], v227, s[40:43], s64 offen offset:3072 sc1
    s_mov_b32 s64, 36864
    buffer_load_dwordx4 v[160:163], v227, s[40:43], s64 offen offset:2560 sc1
    s_mov_b32 s64, 40960
    buffer_load_dwordx4 v[164:167], v227, s[40:43], s64 offen offset:2048 sc1
    s_mov_b32 s64, 45056
    buffer_load_dwordx4 v[168:171], v227, s[40:43], s64 offen offset:1536 sc1
    s_mov_b32 s64, 49152
    buffer_load_dwordx4 v[172:175], v227, s[40:43], s64 offen offset:1024 sc1
    s_mov_b32 s64, 53248
    buffer_load_dwordx4 v[176:179], v227, s[40:43], s64 offen offset:512 sc1
    s_mov_b64 exec, -1
    v_pk_fma_f32 v[116:117], v[202:203], v[194:195], v[116:117] op_sel_hi:[1,0,1]
    v_pk_fma_f32 v[118:119], v[204:205], v[194:195], v[118:119] op_sel_hi:[1,0,1]
    v_pk_mul_f32 v[68:69], v[116:117], v[198:199] op_sel_hi:[1,0]
    v_pk_fma_f32 v[116:117], v[116:117], v[190:191], s[76:77] op_sel_hi:[1,0,1]
    v_exp_f32 v68, v68 clamp
    v_exp_f32 v69, v69 clamp
    v_max_f32 v116, s79, v116
    v_max_f32 v117, s79, v117
    v_pk_add_f32 v[116:117], v[116:117], v[68:69]
    v_pk_mul_f32 v[70:71], v[118:119], v[198:199] op_sel_hi:[1,0]
    v_pk_fma_f32 v[118:119], v[118:119], v[190:191], s[76:77] op_sel_hi:[1,0,1]
    v_exp_f32 v70, v70 clamp
    v_exp_f32 v71, v71 clamp
    v_max_f32 v118, s79, v118
    v_max_f32 v119, s79, v119
    v_pk_add_f32 v[118:119], v[118:119], v[70:71]
    v_cvt_pk_bf16_f32 v36, v116, v117
    v_cvt_pk_bf16_f32 v37, v118, v119
    v_pk_fma_f32 v[120:121], v[206:207], v[194:195], v[120:121] op_sel_hi:[1,0,1]
    v_pk_fma_f32 v[122:123], v[208:209], v[194:195], v[122:123] op_sel_hi:[1,0,1]
    v_pk_mul_f32 v[68:69], v[120:121], v[198:199] op_sel_hi:[1,0]
    v_pk_fma_f32 v[120:121], v[120:121], v[190:191], s[76:77] op_sel_hi:[1,0,1]
    v_exp_f32 v68, v68 clamp
    v_exp_f32 v69, v69 clamp
    v_max_f32 v120, s79, v120
    v_max_f32 v121, s79, v121
    v_pk_add_f32 v[120:121], v[120:121], v[68:69]
    v_pk_mul_f32 v[70:71], v[122:123], v[198:199] op_sel_hi:[1,0]
    v_pk_fma_f32 v[122:123], v[122:123], v[190:191], s[76:77] op_sel_hi:[1,0,1]
    v_exp_f32 v70, v70 clamp
    v_exp_f32 v71, v71 clamp
    v_max_f32 v122, s79, v122
    v_max_f32 v123, s79, v123
    v_pk_add_f32 v[122:123], v[122:123], v[70:71]
    v_cvt_pk_bf16_f32 v38, v120, v121
    v_cvt_pk_bf16_f32 v39, v122, v123
    v_pk_fma_f32 v[124:125], v[210:211], v[194:195], v[124:125] op_sel_hi:[1,0,1]
    v_pk_fma_f32 v[126:127], v[212:213], v[194:195], v[126:127] op_sel_hi:[1,0,1]
    v_pk_mul_f32 v[68:69], v[124:125], v[198:199] op_sel_hi:[1,0]
    v_pk_fma_f32 v[124:125], v[124:125], v[190:191], s[76:77] op_sel_hi:[1,0,1]
    v_exp_f32 v68, v68 clamp
    v_exp_f32 v69, v69 clamp
    v_max_f32 v124, s79, v124
    v_max_f32 v125, s79, v125
    v_pk_add_f32 v[124:125], v[124:125], v[68:69]
    v_pk_mul_f32 v[70:71], v[126:127], v[198:199] op_sel_hi:[1,0]
    v_pk_fma_f32 v[126:127], v[126:127], v[190:191], s[76:77] op_sel_hi:[1,0,1]
    v_exp_f32 v70, v70 clamp
    v_exp_f32 v71, v71 clamp
    v_max_f32 v126, s79, v126
    v_max_f32 v127, s79, v127
    v_pk_add_f32 v[126:127], v[126:127], v[70:71]
    v_cvt_pk_bf16_f32 v40, v124, v125
    v_cvt_pk_bf16_f32 v41, v126, v127
    v_mov_b64 v[42:43], 0
    v_pk_fma_f32 v[128:129], v[202:203], v[196:197], v[128:129] op_sel_hi:[1,0,1]
    v_pk_fma_f32 v[130:131], v[204:205], v[196:197], v[130:131] op_sel_hi:[1,0,1]
    v_pk_mul_f32 v[68:69], v[128:129], v[200:201] op_sel_hi:[1,0]
    v_pk_fma_f32 v[128:129], v[128:129], v[192:193], s[76:77] op_sel_hi:[1,0,1]
    v_exp_f32 v68, v68 clamp
    v_exp_f32 v69, v69 clamp
    v_max_f32 v128, s79, v128
    v_max_f32 v129, s79, v129
    v_pk_add_f32 v[128:129], v[128:129], v[68:69]
    v_pk_mul_f32 v[70:71], v[130:131], v[200:201] op_sel_hi:[1,0]
    v_pk_fma_f32 v[130:131], v[130:131], v[192:193], s[76:77] op_sel_hi:[1,0,1]
    v_exp_f32 v70, v70 clamp
    v_exp_f32 v71, v71 clamp
    v_max_f32 v130, s79, v130
    v_max_f32 v131, s79, v131
    v_pk_add_f32 v[130:131], v[130:131], v[70:71]
    v_cvt_pk_bf16_f32 v44, v128, v129
    v_cvt_pk_bf16_f32 v45, v130, v131
    v_pk_fma_f32 v[132:133], v[206:207], v[196:197], v[132:133] op_sel_hi:[1,0,1]
    v_pk_fma_f32 v[134:135], v[208:209], v[196:197], v[134:135] op_sel_hi:[1,0,1]
    v_pk_mul_f32 v[68:69], v[132:133], v[200:201] op_sel_hi:[1,0]
    v_pk_fma_f32 v[132:133], v[132:133], v[192:193], s[76:77] op_sel_hi:[1,0,1]
    v_exp_f32 v68, v68 clamp
    v_exp_f32 v69, v69 clamp
    v_max_f32 v132, s79, v132
    v_max_f32 v133, s79, v133
    v_pk_add_f32 v[132:133], v[132:133], v[68:69]
    v_pk_mul_f32 v[70:71], v[134:135], v[200:201] op_sel_hi:[1,0]
    v_pk_fma_f32 v[134:135], v[134:135], v[192:193], s[76:77] op_sel_hi:[1,0,1]
    v_exp_f32 v70, v70 clamp
    v_exp_f32 v71, v71 clamp
    v_max_f32 v134, s79, v134
    v_max_f32 v135, s79, v135
    v_pk_add_f32 v[134:135], v[134:135], v[70:71]
    v_cvt_pk_bf16_f32 v46, v132, v133
    v_cvt_pk_bf16_f32 v47, v134, v135
    v_pk_fma_f32 v[136:137], v[210:211], v[196:197], v[136:137] op_sel_hi:[1,0,1]
    v_pk_fma_f32 v[138:139], v[212:213], v[196:197], v[138:139] op_sel_hi:[1,0,1]
    v_pk_mul_f32 v[68:69], v[136:137], v[200:201] op_sel_hi:[1,0]
    v_pk_fma_f32 v[136:137], v[136:137], v[192:193], s[76:77] op_sel_hi:[1,0,1]
    v_exp_f32 v68, v68 clamp
    v_exp_f32 v69, v69 clamp
    v_max_f32 v136, s79, v136
    v_max_f32 v137, s79, v137
    v_pk_add_f32 v[136:137], v[136:137], v[68:69]
    v_pk_mul_f32 v[70:71], v[138:139], v[200:201] op_sel_hi:[1,0]
    v_pk_fma_f32 v[138:139], v[138:139], v[192:193], s[76:77] op_sel_hi:[1,0,1]
    v_exp_f32 v70, v70 clamp
    v_exp_f32 v71, v71 clamp
    v_max_f32 v138, s79, v138
    v_max_f32 v139, s79, v139
    v_pk_add_f32 v[138:139], v[138:139], v[70:71]
    v_cvt_pk_bf16_f32 v48, v136, v137
    v_cvt_pk_bf16_f32 v49, v138, v139
    v_mov_b64 v[50:51], 0
    s_mov_b32 s96, 0
    s_branch KV_chk
KV_poll:
    buffer_load_dwordx2 v[230:231], v232, s[40:43], s53 offen sc1
    s_mov_b64 exec, s[10:11]
    s_mov_b32 s64, 0
    buffer_load_dwordx4 v[76:79], v227, s[40:43], s64 offen offset:0 sc1
    s_mov_b32 s64, 0
    buffer_load_dwordx4 v[80:83], v227, s[40:43], s64 offen offset:3584 sc1
    s_mov_b32 s64, 4096
    buffer_load_dwordx4 v[84:87], v227, s[40:43], s64 offen offset:3072 sc1
    s_mov_b32 s64, 8192
    buffer_load_dwordx4 v[88:91], v227, s[40:43], s64 offen offset:2560 sc1
    s_mov_b32 s64, 12288
    buffer_load_dwordx4 v[92:95], v227, s[40:43], s64 offen offset:2048 sc1
    s_mov_b32 s64, 16384
    buffer_load_dwordx4 v[96:99], v227, s[40:43], s64 offen offset:1536 sc1
    s_mov_b32 s64, 20480
    buffer_load_dwordx4 v[100:103], v227, s[40:43], s64 offen offset:1024 sc1
    s_mov_b32 s64, 24576
    buffer_load_dwordx4 v[104:107], v227, s[40:43], s64 offen offset:512 sc1
    s_mov_b32 s64, 28672
    buffer_load_dwordx4 v[108:111], v227, s[40:43], s64 offen offset:0 sc1
    s_mov_b32 s64, 28672
    buffer_load_dwordx4 v[112:115], v227, s[40:43], s64 offen offset:3584 sc1
    s_mov_b32 s64, 32768
    buffer_load_dwordx4 v[156:159], v227, s[40:43], s64 offen offset:3072 sc1
    s_mov_b32 s64, 36864
    buffer_load_dwordx4 v[160:163], v227, s[40:43], s64 offen offset:2560 sc1
    s_mov_b32 s64, 40960
    buffer_load_dwordx4 v[164:167], v227, s[40:43], s64 offen offset:2048 sc1
    s_mov_b32 s64, 45056
    buffer_load_dwordx4 v[168:171], v227, s[40:43], s64 offen offset:1536 sc1
    s_mov_b32 s64, 49152
    buffer_load_dwordx4 v[172:175], v227, s[40:43], s64 offen offset:1024 sc1
    s_mov_b32 s64, 53248
    buffer_load_dwordx4 v[176:179], v227, s[40:43], s64 offen offset:512 sc1
    s_mov_b64 exec, -1
KV_chk:
    s_mov_b64 exec, s[10:11]
    s_waitcnt vmcnt(14)
    v_pk_add_f32 v[140:141], v[76:77], v[80:81]
    v_pk_add_f32 v[142:143], v[78:79], v[82:83]
    v_max3_u32 v144, v76, v77, v78
    v_max3_u32 v145, v79, v80, v81
    v_max3_u32 v144, v144, v82, v83
    s_waitcnt vmcnt(12)
    v_pk_add_f32 v[140:141], v[140:141], v[84:85]
    v_pk_add_f32 v[142:143], v[142:143], v[86:87]
    v_max3_u32 v144, v144, v84, v85
    v_max3_u32 v145, v145, v86, v87
    v_pk_add_f32 v[140:141], v[140:141], v[88:89]
    v_pk_add_f32 v[142:143], v[142:143], v[90:91]
    v_max3_u32 v144, v144, v88, v89
    v_max3_u32 v145, v145, v90, v91
    s_waitcnt vmcnt(10)
    v_pk_add_f32 v[140:141], v[140:141], v[92:93]
    v_pk_add_f32 v[142:143], v[142:143], v[94:95]
    v_max3_u32 v144, v144, v92, v93
    v_max3_u32 v145, v145, v94, v95
    v_pk_add_f32 v[140:141], v[140:141], v[96:97]
    v_pk_add_f32 v[142:143], v[142:143], v[98:99]
    v_max3_u32 v144, v144, v96, v97
    v_max3_u32 v145, v145, v98, v99
    s_waitcnt vmcnt(8)
    v_pk_add_f32 v[140:141], v[140:141], v[100:101]
    v_pk_add_f32 v[142:143], v[142:143], v[102:103]
    v_max3_u32 v144, v144, v100, v101
    v_max3_u32 v145, v145, v102, v103
    v_pk_add_f32 v[140:141], v[140:141], v[104:105]
    v_pk_add_f32 v[142:143], v[142:143], v[106:107]
    v_max3_u32 v144, v144, v104, v105
    v_max3_u32 v145, v145, v106, v107
    s_waitcnt vmcnt(6)
    v_pk_add_f32 v[140:141], v[140:141], v[108:109]
    v_pk_add_f32 v[142:143], v[142:143], v[110:111]
    v_max3_u32 v144, v144, v108, v109
    v_max3_u32 v145, v145, v110, v111
    v_pk_add_f32 v[140:141], v[140:141], v[112:113]
    v_pk_add_f32 v[142:143], v[142:143], v[114:115]
    v_max3_u32 v144, v144, v112, v113
    v_max3_u32 v145, v145, v114, v115
    s_waitcnt vmcnt(4)
    v_pk_add_f32 v[140:141], v[140:141], v[156:157]
    v_pk_add_f32 v[142:143], v[142:143], v[158:159]
    v_max3_u32 v144, v144, v156, v157
    v_max3_u32 v145, v145, v158, v159
    v_pk_add_f32 v[140:141], v[140:141], v[160:161]
    v_pk_add_f32 v[142:143], v[142:143], v[162:163]
    v_max3_u32 v144, v144, v160, v161
    v_max3_u32 v145, v145, v162, v163
    s_waitcnt vmcnt(2)
    v_pk_add_f32 v[140:141], v[140:141], v[164:165]
    v_pk_add_f32 v[142:143], v[142:143], v[166:167]
    v_max3_u32 v144, v144, v164, v165
    v_max3_u32 v145, v145, v166, v167
    v_pk_add_f32 v[140:141], v[140:141], v[168:169]
    v_pk_add_f32 v[142:143], v[142:143], v[170:171]
    v_max3_u32 v144, v144, v168, v169
    v_max3_u32 v145, v145, v170, v171
    s_waitcnt vmcnt(0)
    v_pk_add_f32 v[140:141], v[140:141], v[172:173]
    v_pk_add_f32 v[142:143], v[142:143], v[174:175]
    v_max3_u32 v144, v144, v172, v173
    v_max3_u32 v145, v145, v174, v175
    v_pk_add_f32 v[140:141], v[140:141], v[176:177]
    v_pk_add_f32 v[142:143], v[142:143], v[178:179]
    v_max3_u32 v144, v144, v176, v177
    v_max3_u32 v145, v145, v178, v179
    v_max_u32 v144, v144, v145
    v_cmp_eq_u32 s[62:63], -1, v144
    s_mov_b64 exec, -1
    v_cmp_ne_u64 vcc, s[94:95], v[230:231]
    s_add_u32 s96, s96, 1
    s_or_b64 vcc, vcc, s[62:63]
    s_cbranch_vccz KV_done
    s_cmp_lt_u32 s96, 40000
    s_cbranch_scc1 KV_poll
KV_done:
    v_cvt_pk_bf16_f32 v140, v140, v141
    v_cvt_pk_bf16_f32 v141, v142, v143
    s_mov_b64 exec, s[10:11]
    ds_write_b64 v228, v[140:141]
    s_mov_b64 exec, -1
    s_waitcnt lgkmcnt(0)
    s_barrier
    ds_read_b128 v[124:127], v17 offset:0
    ds_read_b128 v[100:103], v16 offset:0
    ds_read_b128 v[128:131], v17 offset:64
    ds_read_b128 v[104:107], v16 offset:64
    ds_read_b128 v[132:135], v18 offset:0
    ds_read_b128 v[108:111], v16 offset:2048
    ds_read_b128 v[136:139], v18 offset:64
    ds_read_b128 v[112:115], v16 offset:2112
    ds_read_b128 v[140:143], v19 offset:0
    ds_read_b128 v[116:119], v16 offset:4096
    ds_read_b128 v[144:147], v19 offset:64
    ds_read_b128 v[120:123], v16 offset:4160
    s_add_u32 m0, s60, 0
    s_nop 0
    buffer_load_dwordx4 v233, s[32:35], s58 offen lds
    s_add_u32 m0, s60, 4096
    s_nop 0
    buffer_load_dwordx4 v234, s[32:35], s58 offen lds
    s_add_u32 m0, s60, 8192
    s_nop 0
    buffer_load_dwordx4 v235, s[32:35], s59 offen lds
    buffer_load_dwordx4 a[0:3], v2, s[40:43], s56 offen offset:0 sc1
    buffer_load_dwordx4 a[4:7], v2, s[40:43], s57 offen offset:0 sc1
    buffer_load_dwordx4 a[8:11], v2, s[40:43], s57 offen offset:1024 sc1
    buffer_load_dwordx4 a[12:15], v2, s[40:43], s57 offen offset:2048 sc1
    buffer_load_dwordx4 a[16:19], v2, s[40:43], s57 offen offset:3072 sc1
    s_add_u32 s57, s57, 4096
    s_waitcnt lgkmcnt(8)
    v_mfma_f32_16x16x32_bf16 v[76:79], v[124:127], v[36:39], 0
    buffer_load_dwordx4 a[20:23], v2, s[40:43], s57 offen offset:0 sc1
    v_mfma_f32_16x16x32_bf16 v[80:83], v[124:127], v[44:47], 0
    buffer_load_dwordx4 a[24:27], v2, s[40:43], s57 offen offset:1024 sc1
    v_mfma_f32_16x16x32_bf16 v[76:79], v[128:131], v[40:43], v[76:79]
    buffer_load_dwordx4 a[28:31], v2, s[40:43], s57 offen offset:2048 sc1
    v_mfma_f32_16x16x32_bf16 v[80:83], v[128:131], v[48:51], v[80:83]
    buffer_load_dwordx4 a[32:35], v2, s[40:43], s57 offen offset:3072 sc1
    v_mfma_f32_16x16x32_bf16 v[156:159], v[100:103], v[36:39], 0
    s_add_u32 s57, s57, 4096
    v_mfma_f32_16x16x32_bf16 v[160:163], v[100:103], v[44:47], 0
    v_mfma_f32_16x16x32_bf16 v[156:159], v[104:107], v[40:43], v[156:159]
    v_mfma_f32_16x16x32_bf16 v[160:163], v[104:107], v[48:51], v[160:163]
    s_waitcnt lgkmcnt(4)
    v_mfma_f32_16x16x32_bf16 v[84:87], v[132:135], v[36:39], 0
    v_mfma_f32_16x16x32_bf16 v[88:91], v[132:135], v[44:47], 0
    v_mfma_f32_16x16x32_bf16 v[84:87], v[136:139], v[40:43], v[84:87]
    v_mfma_f32_16x16x32_bf16 v[88:91], v[136:139], v[48:51], v[88:91]
    v_mfma_f32_16x16x32_bf16 v[164:167], v[108:111], v[36:39], 0
    v_mfma_f32_16x16x32_bf16 v[168:171], v[108:111], v[44:47], 0
    v_mfma_f32_16x16x32_bf16 v[164:167], v[112:115], v[40:43], v[164:167]
    v_mfma_f32_16x16x32_bf16 v[168:171], v[112:115], v[48:51], v[168:171]
    s_waitcnt lgkmcnt(0)
    v_mfma_f32_16x16x32_bf16 v[92:95], v[140:143], v[36:39], 0
    v_mfma_f32_16x16x32_bf16 v[96:99], v[140:143], v[44:47], 0
    v_mfma_f32_16x16x32_bf16 v[92:95], v[144:147], v[40:43], v[92:95]
    v_mfma_f32_16x16x32_bf16 v[96:99], v[144:147], v[48:51], v[96:99]
    v_mfma_f32_16x16x32_bf16 v[172:175], v[116:119], v[36:39], 0
    v_mfma_f32_16x16x32_bf16 v[176:179], v[116:119], v[44:47], 0
    v_mfma_f32_16x16x32_bf16 v[172:175], v[120:123], v[40:43], v[172:175]
    v_mfma_f32_16x16x32_bf16 v[176:179], v[120:123], v[48:51], v[176:179]
    v_pk_add_f32 v[76:77], v[76:77], s[76:77]
    v_pk_add_f32 v[78:79], v[78:79], s[76:77]
    v_pk_add_f32 v[80:81], v[80:81], s[76:77]
    v_pk_add_f32 v[82:83], v[82:83], s[76:77]
    v_rcp_f32 v76, v76
    v_rcp_f32 v77, v77
    v_rcp_f32 v78, v78
    v_rcp_f32 v79, v79
    v_rcp_f32 v80, v80
    v_rcp_f32 v81, v81
    v_rcp_f32 v82, v82
    v_rcp_f32 v83, v83
    v_pk_mul_f32 v[156:157], v[156:157], v[76:77]
    v_pk_mul_f32 v[158:159], v[158:159], v[78:79]
    v_pk_mul_f32 v[160:161], v[160:161], v[80:81]
    v_pk_mul_f32 v[162:163], v[162:163], v[82:83]
    v_cvt_pk_bf16_f32 v56, v156, v157
    v_cvt_pk_bf16_f32 v57, v158, v159
    v_cvt_pk_bf16_f32 v58, v160, v161
    v_cvt_pk_bf16_f32 v59, v162, v163
    s_nop 0
    v_permlane16_swap_b32 v56, v58
    v_permlane16_swap_b32 v57, v59
    buffer_store_dwordx4 v[56:59], v236, s[40:43], s4 offen offset:0 sc1
    v_pk_add_f32 v[84:85], v[84:85], s[76:77]
    v_pk_add_f32 v[86:87], v[86:87], s[76:77]
    v_pk_add_f32 v[88:89], v[88:89], s[76:77]
    v_pk_add_f32 v[90:91], v[90:91], s[76:77]
    v_rcp_f32 v84, v84
    v_rcp_f32 v85, v85
    v_rcp_f32 v86, v86
    v_rcp_f32 v87, v87
    v_rcp_f32 v88, v88
    v_rcp_f32 v89, v89
    v_rcp_f32 v90, v90
    v_rcp_f32 v91, v91
    v_pk_mul_f32 v[164:165], v[164:165], v[84:85]
    v_pk_mul_f32 v[166:167], v[166:167], v[86:87]
    v_pk_mul_f32 v[168:169], v[168:169], v[88:89]
    v_pk_mul_f32 v[170:171], v[170:171], v[90:91]
    v_cvt_pk_bf16_f32 v60, v164, v165
    v_cvt_pk_bf16_f32 v61, v166, v167
    v_cvt_pk_bf16_f32 v62, v168, v169
    v_cvt_pk_bf16_f32 v63, v170, v171
    s_nop 0
    v_permlane16_swap_b32 v60, v62
    v_permlane16_swap_b32 v61, v63
    buffer_store_dwordx4 v[60:63], v236, s[40:43], s4 offen offset:512 sc1
    v_pk_add_f32 v[92:93], v[92:93], s[76:77]
    v_pk_add_f32 v[94:95], v[94:95], s[76:77]
    v_pk_add_f32 v[96:97], v[96:97], s[76:77]
    v_pk_add_f32 v[98:99], v[98:99], s[76:77]
    v_rcp_f32 v92, v92
    v_rcp_f32 v93, v93
    v_rcp_f32 v94, v94
    v_rcp_f32 v95, v95
    v_rcp_f32 v96, v96
    v_rcp_f32 v97, v97
    v_rcp_f32 v98, v98
    v_rcp_f32 v99, v99
    v_pk_mul_f32 v[172:173], v[172:173], v[92:93]
    v_pk_mul_f32 v[174:175], v[174:175], v[94:95]
    v_pk_mul_f32 v[176:177], v[176:177], v[96:97]
    v_pk_mul_f32 v[178:179], v[178:179], v[98:99]
    v_cvt_pk_bf16_f32 v64, v172, v173
    v_cvt_pk_bf16_f32 v65, v174, v175
    v_cvt_pk_bf16_f32 v66, v176, v177
    v_cvt_pk_bf16_f32 v67, v178, v179
    s_nop 0
    v_permlane16_swap_b32 v64, v66
    v_permlane16_swap_b32 v65, v67
    s_mov_b64 exec, 0xffffffff
    buffer_store_dwordx4 v[64:67], v236, s[40:43], s4 offen offset:1024 sc1
    s_mov_b64 exec, -1
    s_lshl_b32 s66, s30, 7
    s_add_u32 s66, s66, 16060416
    s_lshl_b32 s97, s31, 3
    buffer_load_dwordx4 a[36:39], v2, s[40:43], s57 offen offset:0 sc1
    s_add_u32 s97, s97, s66
    s_mul_i32 s61, s26, 20
    s_lshl_b32 s62, s28, 2
    buffer_load_dwordx4 a[40:43], v2, s[40:43], s57 offen offset:1024 sc1
    s_add_u32 s60, s26, 0
    s_and_b32 s60, s60, 3
    s_mul_i32 s64, s60, 15360
    buffer_load_dwordx4 a[44:47], v2, s[40:43], s57 offen offset:2048 sc1
    s_add_u32 s64, s64, 77824
    v_add_u32 v11, s64, v2
    s_add_u32 s60, s60, s62
    buffer_load_dwordx4 a[48:51], v2, s[40:43], s57 offen offset:3072 sc1
    s_add_u32 s57, s57, 4096
    s_mul_i32 s60, s60, 80
    s_add_u32 s60, s60, s61
    s_lshl_b32 s60, s60, 8
    buffer_load_dwordx4 a[52:55], v2, s[40:43], s57 offen offset:0 sc1
    s_add_u32 s52, s60, 0
    s_add_u32 s60, s26, 1
    s_and_b32 s60, s60, 3
    buffer_load_dwordx4 a[56:59], v2, s[40:43], s57 offen offset:1024 sc1
    s_mul_i32 s64, s60, 15360
    s_add_u32 s64, s64, 77824
    v_add_u32 v13, s64, v2
    buffer_load_dwordx4 a[60:63], v2, s[40:43], s57 offen offset:2048 sc1
    s_add_u32 s60, s60, s62
    s_mul_i32 s60, s60, 80
    s_add_u32 s60, s60, s61
    buffer_load_dwordx4 a[64:67], v2, s[40:43], s57 offen offset:3072 sc1
    s_add_u32 s57, s57, 4096
    s_lshl_b32 s60, s60, 8
    s_add_u32 s53, s60, 0
    s_add_u32 s60, s26, 2
    s_and_b32 s60, s60, 3
    s_mul_i32 s64, s60, 15360
    s_add_u32 s64, s64, 82944
    v_add_u32 v14, s64, v2
    s_add_u32 s60, s60, s62
    s_mul_i32 s60, s60, 80
    s_add_u32 s60, s60, s61
    s_lshl_b32 s60, s60, 8
    s_add_u32 s54, s60, 0
    s_add_u32 s60, s26, 3
    s_and_b32 s60, s60, 3
    s_mul_i32 s64, s60, 15360
    s_add_u32 s64, s64, 88064
    v_add_u32 v15, s64, v2
    s_add_u32 s60, s60, s62
    s_mul_i32 s60, s60, 80
    s_add_u32 s60, s60, s61
    s_lshl_b32 s60, s60, 8
    s_add_u32 s55, s60, 0
    v_mov_b64 v[192:193], v[214:215]
    v_mov_b64 v[194:195], v[216:217]
    v_mov_b64 v[196:197], v[218:219]
    v_and_b32 v4, 15, v1
    v_lshrrev_b32 v5, 4, v1
    s_mul_i32 s62, s26, 2560
    s_add_u32 s62, s62, 139264
    v_mul_u32_u24 v9, 160, v4
    v_lshl_add_u32 v9, v5, 3, v9
    v_add_u32 v9, s62, v9
    s_waitcnt vmcnt(8)
    s_barrier
    s_cmp_lg_u32 s26, 0
    s_cbranch_scc1 nf_5
    s_mov_b64 exec, 1
    s_cmp_lg_u32 s84, 1
    s_cbranch_scc1 sl_6
    buffer_store_dwordx2 v[242:243], v244, s[40:43], s97 offen
    s_mov_b64 exec, -1
    s_branch nf_5
sl_6:
    buffer_wbl2 sc1
    s_waitcnt vmcnt(0)
    buffer_store_dwordx2 v[242:243], v244, s[40:43], s97 offen sc1
    s_mov_b64 exec, -1
nf_5:
    s_mov_b32 s96, 0
pl_7:
    buffer_load_dwordx2 v[18:19], v239, s[40:43], s66 offen sc1
    s_waitcnt vmcnt(0)
    v_cmp_ne_u64 vcc, s[94:95], v[18:19]
    s_add_u32 s96, s96, 1
    s_cbranch_vccz pd_8
    s_cmp_lt_u32 s96, 40000
    s_cbranch_scc1 pl_7
pd_8:
    buffer_load_dwordx4 v[120:123], v2, s[40:43], s53 offen offset:0 sc1
    buffer_load_dwordx4 v[124:127], v2, s[40:43], s53 offen offset:1024 sc1
    buffer_load_dwordx4 v[128:131], v2, s[40:43], s53 offen offset:2048 sc1
    buffer_load_dwordx4 v[132:135], v2, s[40:43], s53 offen offset:3072 sc1
    s_add_u32 s53, s53, 4096
    buffer_load_dwordx4 v[136:139], v2, s[40:43], s53 offen offset:0 sc1
    buffer_load_dwordx4 v[140:143], v2, s[40:43], s54 offen offset:0 sc1
    buffer_load_dwordx4 v[144:147], v2, s[40:43], s54 offen offset:1024 sc1
    buffer_load_dwordx4 v[148:151], v2, s[40:43], s54 offen offset:2048 sc1
    buffer_load_dwordx4 v[152:155], v2, s[40:43], s54 offen offset:3072 sc1
    s_add_u32 s54, s54, 4096
    buffer_load_dwordx4 v[156:159], v2, s[40:43], s54 offen offset:0 sc1
    ds_read_b64 v[24:25], v9 offset:0
    ds_read_b64 v[26:27], v9 offset:32
    ds_read_b64 v[28:29], v9 offset:64
    ds_read_b64 v[30:31], v9 offset:96
    ds_read_b64 v[32:33], v9 offset:128
    v_lshrrev_b32 v6, 2, v1
    v_mul_u32_u24 v6, 192, v6
    v_and_b32 v7, 3, v1
    v_lshl_add_u32 v6, v7, 3, v6
    v_and_b32 v7, 1, v5
    s_mul_i32 s62, s26, 5
    s_add_u32 s62, s62, 1
    s_mul_i32 s62, s62, 43
    s_lshr_b32 s62, s62, 7
    v_xor_b32 v220, s62, v7
    v_lshl_add_u32 v220, v220, 5, v6
    s_lshr_b32 s62, s26, 1
    s_mul_i32 s62, s62, 3
    s_add_u32 s62, s62, 1
    s_and_b32 s63, s26, 1
    s_mul_i32 s63, s63, 6144
    v_xor_b32 v221, s62, v7
    v_lshl_add_u32 v221, v221, 5, v6
    v_add_u32 v221, s63, v221
    v_add_u32 v222, 61440, v220
    v_add_u32 v223, 61440, v221
    v_lshlrev_b32 v7, 5, v7
    v_add_u32 v12, v6, v7
    v_sub_u32 v16, v6, v7
    s_waitcnt lgkmcnt(0)
    v_lshlrev_b32 v224, 16, v24
    v_and_b32 v225, 0xffff0000, v24
    v_lshlrev_b32 v226, 16, v25
    v_and_b32 v227, 0xffff0000, v25
    v_lshlrev_b32 v228, 16, v26
    v_and_b32 v229, 0xffff0000, v26
    v_lshlrev_b32 v230, 16, v27
    v_and_b32 v231, 0xffff0000, v27
    v_lshlrev_b32 v232, 16, v28
    v_and_b32 v233, 0xffff0000, v28
    v_lshlrev_b32 v234, 16, v29
    v_and_b32 v235, 0xffff0000, v29
    v_lshlrev_b32 v200, 16, v30
    v_and_b32 v201, 0xffff0000, v30
    v_lshlrev_b32 v202, 16, v31
    v_and_b32 v203, 0xffff0000, v31
    v_lshlrev_b32 v204, 16, v32
    v_and_b32 v205, 0xffff0000, v32
    v_lshlrev_b32 v206, 16, v33
    v_and_b32 v207, 0xffff0000, v33
    v_add_u32 v17, 61440, v12
    v_add_u32 v9, 61440, v16
    s_waitcnt vmcnt(9)
    v_mfma_f32_16x16x32_bf16 v[60:63], a[160:163], v[120:123], 0
    buffer_load_dwordx4 v[160:163], v2, s[40:43], s55 offen offset:0 sc1
    v_mfma_f32_16x16x32_bf16 v[64:67], a[164:167], v[120:123], 0
    v_mfma_f32_16x16x32_bf16 v[68:71], a[168:171], v[120:123], 0
    v_mfma_f32_16x16x32_bf16 v[72:75], a[172:175], v[120:123], 0
    v_mfma_f32_16x16x32_bf16 v[76:79], a[176:179], v[120:123], 0
    s_waitcnt vmcnt(9)
    v_mfma_f32_16x16x32_bf16 v[60:63], a[180:183], v[124:127], v[60:63]
    buffer_load_dwordx4 v[164:167], v2, s[40:43], s55 offen offset:1024 sc1
    v_mfma_f32_16x16x32_bf16 v[64:67], a[184:187], v[124:127], v[64:67]
    v_mfma_f32_16x16x32_bf16 v[68:71], a[188:191], v[124:127], v[68:71]
    v_mfma_f32_16x16x32_bf16 v[72:75], a[192:195], v[124:127], v[72:75]
    v_mfma_f32_16x16x32_bf16 v[76:79], a[196:199], v[124:127], v[76:79]
    s_waitcnt vmcnt(9)
    v_mfma_f32_16x16x32_bf16 v[60:63], a[200:203], v[128:131], v[60:63]
    buffer_load_dwordx4 v[168:171], v2, s[40:43], s55 offen offset:2048 sc1
    v_mfma_f32_16x16x32_bf16 v[64:67], a[204:207], v[128:131], v[64:67]
    v_mfma_f32_16x16x32_bf16 v[68:71], a[208:211], v[128:131], v[68:71]
    v_mfma_f32_16x16x32_bf16 v[72:75], a[212:215], v[128:131], v[72:75]
    v_mfma_f32_16x16x32_bf16 v[76:79], a[216:219], v[128:131], v[76:79]
    s_waitcnt vmcnt(9)
    v_mfma_f32_16x16x32_bf16 v[60:63], a[220:223], v[132:135], v[60:63]
    buffer_load_dwordx4 v[172:175], v2, s[40:43], s55 offen offset:3072 sc1
    v_mfma_f32_16x16x32_bf16 v[64:67], a[224:227], v[132:135], v[64:67]
    s_add_u32 s55, s55, 4096
    v_mfma_f32_16x16x32_bf16 v[68:71], a[228:231], v[132:135], v[68:71]
    v_mfma_f32_16x16x32_bf16 v[72:75], a[232:235], v[132:135], v[72:75]
    v_mfma_f32_16x16x32_bf16 v[76:79], a[236:239], v[132:135], v[76:79]
    s_waitcnt vmcnt(9)
    v_mfma_f32_16x16x32_bf16 v[60:63], a[240:243], v[136:139], v[60:63]
    buffer_load_dwordx4 v[176:179], v2, s[40:43], s55 offen offset:0 sc1
    v_mfma_f32_16x16x32_bf16 v[64:67], a[244:247], v[136:139], v[64:67]
    v_mfma_f32_16x16x32_bf16 v[68:71], a[248:251], v[136:139], v[68:71]
    v_mfma_f32_16x16x32_bf16 v[72:75], a[252:255], v[136:139], v[72:75]
    v_mfma_f32_16x16x32_bf16 v[76:79], a[0:3], v[136:139], v[76:79]
    s_waitcnt vmcnt(9)
    v_mfma_f32_16x16x32_bf16 v[80:83], a[160:163], v[140:143], 0
    buffer_load_dwordx4 v[180:183], v2, s[40:43], s52 offen offset:0 sc1
    v_mfma_f32_16x16x32_bf16 v[84:87], a[164:167], v[140:143], 0
    v_mfma_f32_16x16x32_bf16 v[88:91], a[168:171], v[140:143], 0
    ds_write_b128 v13, v[60:63] offset:0
    v_mfma_f32_16x16x32_bf16 v[92:95], a[172:175], v[140:143], 0
    v_mfma_f32_16x16x32_bf16 v[96:99], a[176:179], v[140:143], 0
    s_waitcnt vmcnt(9)
    v_mfma_f32_16x16x32_bf16 v[80:83], a[180:183], v[144:147], v[80:83]
    buffer_load_dwordx4 v[184:187], v2, s[40:43], s52 offen offset:1024 sc1
    v_mfma_f32_16x16x32_bf16 v[84:87], a[184:187], v[144:147], v[84:87]
    v_mfma_f32_16x16x32_bf16 v[88:91], a[188:191], v[144:147], v[88:91]
    ds_write_b128 v13, v[64:67] offset:1024
    v_mfma_f32_16x16x32_bf16 v[92:95], a[192:195], v[144:147], v[92:95]
    v_mfma_f32_16x16x32_bf16 v[96:99], a[196:199], v[144:147], v[96:99]
    s_waitcnt vmcnt(9)
    v_mfma_f32_16x16x32_bf16 v[80:83], a[200:203], v[148:151], v[80:83]
    buffer_load_dwordx4 v[188:191], v2, s[40:43], s52 offen offset:2048 sc1
    v_mfma_f32_16x16x32_bf16 v[84:87], a[204:207], v[148:151], v[84:87]
    v_mfma_f32_16x16x32_bf16 v[88:91], a[208:211], v[148:151], v[88:91]
    ds_write_b128 v13, v[68:71] offset:2048
    v_mfma_f32_16x16x32_bf16 v[92:95], a[212:215], v[148:151], v[92:95]
    v_mfma_f32_16x16x32_bf16 v[96:99], a[216:219], v[148:151], v[96:99]
    s_waitcnt vmcnt(9)
    v_mfma_f32_16x16x32_bf16 v[80:83], a[220:223], v[152:155], v[80:83]
    buffer_load_dwordx4 v[120:123], v2, s[40:43], s52 offen offset:3072 sc1
    v_mfma_f32_16x16x32_bf16 v[84:87], a[224:227], v[152:155], v[84:87]
    s_add_u32 s52, s52, 4096
    v_mfma_f32_16x16x32_bf16 v[88:91], a[228:231], v[152:155], v[88:91]
    ds_write_b128 v13, v[72:75] offset:3072
    v_mfma_f32_16x16x32_bf16 v[92:95], a[232:235], v[152:155], v[92:95]
    v_mfma_f32_16x16x32_bf16 v[96:99], a[236:239], v[152:155], v[96:99]
    s_waitcnt vmcnt(9)
    v_mfma_f32_16x16x32_bf16 v[80:83], a[240:243], v[156:159], v[80:83]
    buffer_load_dwordx4 v[124:127], v2, s[40:43], s52 offen offset:0 sc1
    v_mfma_f32_16x16x32_bf16 v[84:87], a[244:247], v[156:159], v[84:87]
    buffer_load_dwordx4 a[68:71], v2, s[40:43], s57 offen offset:0 sc1
    v_mfma_f32_16x16x32_bf16 v[88:91], a[248:251], v[156:159], v[88:91]
    ds_write_b128 v13, v[76:79] offset:4096
    v_mfma_f32_16x16x32_bf16 v[92:95], a[252:255], v[156:159], v[92:95]
    v_mfma_f32_16x16x32_bf16 v[96:99], a[0:3], v[156:159], v[96:99]
    s_waitcnt vmcnt(10)
    v_mfma_f32_16x16x32_bf16 v[100:103], a[160:163], v[160:163], 0
    buffer_load_dwordx4 a[72:75], v2, s[40:43], s57 offen offset:1024 sc1
    v_mfma_f32_16x16x32_bf16 v[104:107], a[164:167], v[160:163], 0
    v_mfma_f32_16x16x32_bf16 v[108:111], a[168:171], v[160:163], 0
    ds_write_b128 v14, v[80:83] offset:0
    v_mfma_f32_16x16x32_bf16 v[112:115], a[172:175], v[160:163], 0
    v_mfma_f32_16x16x32_bf16 v[116:119], a[176:179], v[160:163], 0
    s_waitcnt vmcnt(10)
    v_mfma_f32_16x16x32_bf16 v[100:103], a[180:183], v[164:167], v[100:103]
    buffer_load_dwordx4 a[76:79], v2, s[40:43], s57 offen offset:2048 sc1
    v_mfma_f32_16x16x32_bf16 v[104:107], a[184:187], v[164:167], v[104:107]
    v_mfma_f32_16x16x32_bf16 v[108:111], a[188:191], v[164:167], v[108:111]
    ds_write_b128 v14, v[84:87] offset:1024
    v_mfma_f32_16x16x32_bf16 v[112:115], a[192:195], v[164:167], v[112:115]
    v_mfma_f32_16x16x32_bf16 v[116:119], a[196:199], v[164:167], v[116:119]
    s_waitcnt vmcnt(10)
    v_mfma_f32_16x16x32_bf16 v[100:103], a[200:203], v[168:171], v[100:103]
    buffer_load_dwordx4 a[80:83], v2, s[40:43], s57 offen offset:3072 sc1
    v_mfma_f32_16x16x32_bf16 v[104:107], a[204:207], v[168:171], v[104:107]
    s_add_u32 s57, s57, 4096
    v_mfma_f32_16x16x32_bf16 v[108:111], a[208:211], v[168:171], v[108:111]
    ds_write_b128 v14, v[88:91] offset:2048
    v_mfma_f32_16x16x32_bf16 v[112:115], a[212:215], v[168:171], v[112:115]
    v_mfma_f32_16x16x32_bf16 v[116:119], a[216:219], v[168:171], v[116:119]
    s_waitcnt vmcnt(10)
    v_mfma_f32_16x16x32_bf16 v[100:103], a[220:223], v[172:175], v[100:103]
    buffer_load_dwordx4 a[84:87], v2, s[40:43], s57 offen offset:0 sc1
    v_mfma_f32_16x16x32_bf16 v[104:107], a[224:227], v[172:175], v[104:107]
    v_mfma_f32_16x16x32_bf16 v[108:111], a[228:231], v[172:175], v[108:111]
    ds_write_b128 v14, v[92:95] offset:3072
    v_mfma_f32_16x16x32_bf16 v[112:115], a[232:235], v[172:175], v[112:115]
    v_mfma_f32_16x16x32_bf16 v[116:119], a[236:239], v[172:175], v[116:119]
    s_waitcnt vmcnt(10)
    v_mfma_f32_16x16x32_bf16 v[100:103], a[240:243], v[176:179], v[100:103]
    v_mfma_f32_16x16x32_bf16 v[104:107], a[244:247], v[176:179], v[104:107]
    v_mfma_f32_16x16x32_bf16 v[108:111], a[248:251], v[176:179], v[108:111]
    ds_write_b128 v14, v[96:99] offset:4096
    v_mfma_f32_16x16x32_bf16 v[112:115], a[252:255], v[176:179], v[112:115]
    v_mfma_f32_16x16x32_bf16 v[116:119], a[0:3], v[176:179], v[116:119]
    s_waitcnt vmcnt(9)
    v_mfma_f32_16x16x32_bf16 v[40:43], a[160:163], v[180:183], v[224:227]
    v_mfma_f32_16x16x32_bf16 v[44:47], a[164:167], v[180:183], v[228:231]
    v_mfma_f32_16x16x32_bf16 v[48:51], a[168:171], v[180:183], v[232:235]
    ds_write_b128 v15, v[100:103] offset:0
    v_mfma_f32_16x16x32_bf16 v[52:55], a[172:175], v[180:183], v[200:203]
    v_mfma_f32_16x16x32_bf16 v[56:59], a[176:179], v[180:183], v[204:207]
    s_waitcnt vmcnt(8)
    v_mfma_f32_16x16x32_bf16 v[40:43], a[180:183], v[184:187], v[40:43]
    v_mfma_f32_16x16x32_bf16 v[44:47], a[184:187], v[184:187], v[44:47]
    v_mfma_f32_16x16x32_bf16 v[48:51], a[188:191], v[184:187], v[48:51]
    ds_write_b128 v15, v[104:107] offset:1024
    v_mfma_f32_16x16x32_bf16 v[52:55], a[192:195], v[184:187], v[52:55]
    v_mfma_f32_16x16x32_bf16 v[56:59], a[196:199], v[184:187], v[56:59]
    s_waitcnt vmcnt(7)
    v_mfma_f32_16x16x32_bf16 v[40:43], a[200:203], v[188:191], v[40:43]
    v_mfma_f32_16x16x32_bf16 v[44:47], a[204:207], v[188:191], v[44:47]
    v_mfma_f32_16x16x32_bf16 v[48:51], a[208:211], v[188:191], v[48:51]
    ds_write_b128 v15, v[108:111] offset:2048
    v_mfma_f32_16x16x32_bf16 v[52:55], a[212:215], v[188:191], v[52:55]
    v_mfma_f32_16x16x32_bf16 v[56:59], a[216:219], v[188:191], v[56:59]
    s_waitcnt vmcnt(6)
    v_mfma_f32_16x16x32_bf16 v[40:43], a[220:223], v[120:123], v[40:43]
    v_mfma_f32_16x16x32_bf16 v[44:47], a[224:227], v[120:123], v[44:47]
    v_mfma_f32_16x16x32_bf16 v[48:51], a[228:231], v[120:123], v[48:51]
    ds_write_b128 v15, v[112:115] offset:3072
    v_mfma_f32_16x16x32_bf16 v[52:55], a[232:235], v[120:123], v[52:55]
    v_mfma_f32_16x16x32_bf16 v[56:59], a[236:239], v[120:123], v[56:59]
    s_waitcnt vmcnt(5)
    v_mfma_f32_16x16x32_bf16 v[40:43], a[240:243], v[124:127], v[40:43]
    v_mfma_f32_16x16x32_bf16 v[44:47], a[244:247], v[124:127], v[44:47]
    v_mfma_f32_16x16x32_bf16 v[48:51], a[248:251], v[124:127], v[48:51]
    ds_write_b128 v15, v[116:119] offset:4096
    v_mfma_f32_16x16x32_bf16 v[52:55], a[252:255], v[124:127], v[52:55]
    v_mfma_f32_16x16x32_bf16 v[56:59], a[0:3], v[124:127], v[56:59]
    s_waitcnt lgkmcnt(0)
    s_barrier
    ds_read_b128 v[120:123], v11 offset:0
    ds_read_b128 v[124:127], v11 offset:5120
    ds_read_b128 v[128:131], v11 offset:10240
    ds_read_b128 v[132:135], v11 offset:1024
    ds_read_b128 v[136:139], v11 offset:6144
    ds_read_b128 v[140:143], v11 offset:11264
    ds_read_b128 v[144:147], v11 offset:2048
    ds_read_b128 v[148:151], v11 offset:7168
    ds_read_b128 v[152:155], v11 offset:12288
    ds_read_b128 v[156:159], v11 offset:3072
    ds_read_b128 v[160:163], v11 offset:8192
    ds_read_b128 v[164:167], v11 offset:13312
    ds_read_b128 v[168:171], v11 offset:4096
    ds_read_b128 v[172:175], v11 offset:9216
    ds_read_b128 v[176:179], v11 offset:14336
    buffer_load_dwordx4 a[88:91], v2, s[40:43], s57 offen offset:1024 sc1
    buffer_load_dwordx4 a[92:95], v2, s[40:43], s57 offen offset:2048 sc1
    buffer_load_dwordx4 a[96:99], v2, s[40:43], s57 offen offset:3072 sc1
    s_add_u32 s57, s57, 4096
    buffer_load_dwordx4 a[100:103], v2, s[40:43], s57 offen offset:0 sc1
    buffer_load_dwordx4 a[104:107], v2, s[40:43], s57 offen offset:1024 sc1
    buffer_load_dwordx4 a[108:111], v2, s[40:43], s57 offen offset:2048 sc1
    buffer_load_dwordx4 a[112:115], v2, s[40:43], s57 offen offset:3072 sc1
    s_add_u32 s57, s57, 4096
    buffer_load_dwordx4 a[116:119], v2, s[40:43], s57 offen offset:0 sc1
    v_mov_b64 v[36:37], 0
    v_mov_b64 v[34:35], 0
    s_lshl_b32 s66, s30, 7
    s_add_u32 s66, s66, 16062464
    s_lshl_b32 s97, s31, 3
    s_add_u32 s97, s97, s66
    s_waitcnt lgkmcnt(12)
    v_pk_add_f32 v[40:41], v[40:41], v[120:121]
    v_pk_add_f32 v[124:125], v[124:125], v[128:129]
    v_pk_add_f32 v[42:43], v[42:43], v[122:123]
    v_pk_add_f32 v[126:127], v[126:127], v[130:131]
    v_pk_add_f32 v[40:41], v[40:41], v[124:125]
    v_pk_add_f32 v[42:43], v[42:43], v[126:127]
    v_cvt_pk_bf16_f32 v246, v40, v41
    v_cvt_pk_bf16_f32 v247, v42, v43
    s_waitcnt lgkmcnt(9)
    v_pk_add_f32 v[44:45], v[44:45], v[132:133]
    v_pk_add_f32 v[136:137], v[136:137], v[140:141]
    v_pk_add_f32 v[46:47], v[46:47], v[134:135]
    v_pk_add_f32 v[138:139], v[138:139], v[142:143]
    v_pk_add_f32 v[44:45], v[44:45], v[136:137]
    v_pk_add_f32 v[46:47], v[46:47], v[138:139]
    v_cvt_pk_bf16_f32 v248, v44, v45
    v_cvt_pk_bf16_f32 v249, v46, v47
    s_waitcnt lgkmcnt(0)
    s_barrier
    v_mov_b64 v[24:25], v[246:247]
    v_mov_b64 v[26:27], v[248:249]
    s_nop 1
    v_permlane16_swap_b32 v24, v26
    v_permlane16_swap_b32 v25, v27
    buffer_store_dwordx4 v[24:27], v237, s[40:43], s5 offen offset:0 sc1
    v_pk_add_f32 v[48:49], v[48:49], v[144:145]
    v_pk_add_f32 v[148:149], v[148:149], v[152:153]
    v_pk_add_f32 v[50:51], v[50:51], v[146:147]
    v_pk_add_f32 v[150:151], v[150:151], v[154:155]
    v_pk_add_f32 v[48:49], v[48:49], v[148:149]
    v_pk_add_f32 v[50:51], v[50:51], v[150:151]
    v_cvt_pk_bf16_f32 v250, v48, v49
    v_cvt_pk_bf16_f32 v251, v50, v51
    v_pk_add_f32 v[52:53], v[52:53], v[156:157]
    v_pk_add_f32 v[160:161], v[160:161], v[164:165]
    v_pk_add_f32 v[54:55], v[54:55], v[158:159]
    v_pk_add_f32 v[162:163], v[162:163], v[166:167]
    v_pk_add_f32 v[52:53], v[52:53], v[160:161]
    v_pk_add_f32 v[54:55], v[54:55], v[162:163]
    v_cvt_pk_bf16_f32 v252, v52, v53
    v_cvt_pk_bf16_f32 v253, v54, v55
    v_mov_b64 v[28:29], v[250:251]
    v_mov_b64 v[30:31], v[252:253]
    s_nop 1
    v_permlane16_swap_b32 v28, v30
    v_permlane16_swap_b32 v29, v31
    buffer_store_dwordx4 v[28:31], v237, s[40:43], s5 offen offset:1024 sc1
    v_pk_add_f32 v[56:57], v[56:57], v[168:169]
    v_pk_add_f32 v[172:173], v[172:173], v[176:177]
    v_pk_add_f32 v[58:59], v[58:59], v[170:171]
    v_pk_add_f32 v[174:175], v[174:175], v[178:179]
    v_pk_add_f32 v[56:57], v[56:57], v[172:173]
    v_pk_add_f32 v[58:59], v[58:59], v[174:175]
    v_cvt_pk_bf16_f32 v254, v56, v57
    v_cvt_pk_bf16_f32 v255, v58, v59
    v_mov_b64 v[32:33], v[254:255]
    s_nop 1
    v_permlane16_swap_b32 v32, v34
    v_permlane16_swap_b32 v33, v35
    s_mov_b32 exec_lo, 0xffff
    s_mov_b32 exec_hi, 0xffff
    buffer_store_dwordx4 v[32:35], v237, s[40:43], s5 offen offset:2048 sc1
    s_mov_b64 exec, -1
    s_nop 0
    v_dot2_f32_bf16 v32, v246, v20, 0
    v_dot2_f32_bf16 v34, v246, v246, 0
    v_dot2_f32_bf16 v33, v247, v20, 0
    v_dot2_f32_bf16 v35, v247, v247, 0
    v_dot2_f32_bf16 v32, v248, v20, v32
    v_dot2_f32_bf16 v34, v248, v248, v34
    v_dot2_f32_bf16 v33, v249, v20, v33
    v_dot2_f32_bf16 v35, v249, v249, v35
    v_dot2_f32_bf16 v32, v250, v20, v32
    v_dot2_f32_bf16 v34, v250, v250, v34
    v_dot2_f32_bf16 v33, v251, v20, v33
    v_dot2_f32_bf16 v35, v251, v251, v35
    v_dot2_f32_bf16 v32, v252, v20, v32
    v_dot2_f32_bf16 v34, v252, v252, v34
    v_dot2_f32_bf16 v33, v253, v20, v33
    v_dot2_f32_bf16 v35, v253, v253, v35
    v_dot2_f32_bf16 v32, v254, v20, v32
    v_dot2_f32_bf16 v34, v254, v254, v34
    v_dot2_f32_bf16 v33, v255, v20, v33
    v_dot2_f32_bf16 v35, v255, v255, v35
    s_nop 1
    v_add_f32 v36, v32, v33
    v_add_f32 v37, v34, v35
    v_mov_b64 v[34:35], v[36:37]
    s_nop 1
    v_permlane16_swap_b32 v34, v36
    v_permlane16_swap_b32 v35, v37
    v_pk_add_f32 v[36:37], v[36:37], v[34:35]
    v_mov_b64 v[34:35], v[36:37]
    s_nop 1
    v_permlane32_swap_b32 v34, v36
    v_permlane32_swap_b32 v35, v37
    v_pk_add_f32 v[36:37], v[36:37], v[34:35]
    s_mov_b64 exec, 0xffff
    buffer_store_dwordx2 v[36:37], v239, s[40:43], s7 offen sc1
    s_mov_b64 exec, -1
    s_mov_b32 s44, s14
    s_and_b32 s45, s15, 0xffff
    s_mov_b32 s46, 3072
    s_mov_b32 s47, 0x00020000
    s_mul_i32 s59, s31, 192
    v_lshlrev_b32 v7, 3, v5
    buffer_load_dwordx2 v[120:121], v7, s[44:47], s59 offen offset:0
    buffer_load_dwordx2 v[122:123], v7, s[44:47], s59 offen offset:32
    buffer_load_dwordx2 v[124:125], v7, s[44:47], s59 offen offset:64
    buffer_load_dwordx2 v[126:127], v7, s[44:47], s59 offen offset:96
    buffer_load_dwordx2 v[128:129], v7, s[44:47], s59 offen offset:128
    buffer_load_dwordx2 v[130:131], v7, s[44:47], s59 offen offset:160
    buffer_load_dwordx4 a[120:123], v2, s[40:43], s57 offen offset:1024 sc1
    buffer_load_dwordx4 a[124:127], v2, s[40:43], s57 offen offset:2048 sc1
    buffer_load_dwordx4 a[128:131], v2, s[40:43], s57 offen offset:3072 sc1
    s_add_u32 s57, s57, 4096
    buffer_load_dwordx4 a[132:135], v2, s[40:43], s57 offen offset:0 sc1
    buffer_load_dwordx4 a[136:139], v2, s[40:43], s57 offen offset:1024 sc1
    buffer_load_dwordx4 a[140:143], v2, s[40:43], s57 offen offset:2048 sc1
    s_lshl_b32 s54, s30, 3
    s_lshl_b32 s55, s26, 1
    s_add_u32 s54, s54, s55
    s_mul_i32 s54, s54, 21504
    s_add_u32 s54, s54, 2621440
    s_add_u32 s55, s54, 21504
    s_lshl_b32 s52, s30, 7
    s_lshl_b32 s53, s26, 5
    s_add_u32 s52, s52, s53
    s_lshl_b32 s52, s52, 3
    s_add_u32 s52, s52, 15925248
    s_add_u32 s53, s52, 16384
    v_lshlrev_b32 v6, 15, v5
    v_lshl_or_b32 v6, v4, 3, v6
    s_lshl_b32 s60, s26, 7
    s_add_u32 s60, s60, 162048
    v_lshlrev_b32 v7, 4, v5
    v_add_u32 v8, s60, v7
    v_add_u32 v14, 162048, v7
    ds_read_b64_tr_b16 v[48:49], v220 offset:0
    ds_read_b64_tr_b16 v[50:51], v220 offset:3072
    ds_read_b64_tr_b16 v[52:53], v221 offset:0
    ds_read_b64_tr_b16 v[54:55], v221 offset:3072
    ds_read_b64_tr_b16 v[56:57], v220 offset:6144
    ds_read_b64_tr_b16 v[58:59], v220 offset:9216
    ds_read_b64_tr_b16 v[60:61], v220 offset:12288
    ds_read_b64_tr_b16 v[62:63], v220 offset:15360
    ds_read_b64_tr_b16 v[64:65], v221 offset:12288
    ds_read_b64_tr_b16 v[66:67], v221 offset:15360
    ds_read_b64_tr_b16 v[68:69], v220 offset:18432
    ds_read_b64_tr_b16 v[70:71], v220 offset:21504
    ds_read_b64_tr_b16 v[72:73], v220 offset:24576
    ds_read_b64_tr_b16 v[74:75], v220 offset:27648
    s_waitcnt lgkmcnt(12)
    v_mfma_f32_16x16x32_bf16 v[212:215], v[48:51], v[20:23], 0
    ds_read_b64_tr_b16 v[76:77], v221 offset:24576
    ds_read_b64_tr_b16 v[78:79], v221 offset:27648
    s_waitcnt lgkmcnt(12)
    v_mfma_f32_16x16x32_bf16 v[216:219], v[52:55], v[20:23], 0
    ds_read_b64_tr_b16 v[80:81], v220 offset:30720
    ds_read_b64_tr_b16 v[82:83], v220 offset:33792
    s_waitcnt lgkmcnt(12)
    v_mfma_f32_16x16x32_bf16 v[212:215], v[56:59], v[20:23], v[212:215]
    s_waitcnt lgkmcnt(10)
    v_mfma_f32_16x16x32_bf16 v[212:215], v[60:63], v[20:23], v[212:215]
    s_waitcnt lgkmcnt(8)
    v_mfma_f32_16x16x32_bf16 v[216:219], v[64:67], v[20:23], v[216:219]
    s_waitcnt lgkmcnt(6)
    v_mfma_f32_16x16x32_bf16 v[212:215], v[68:71], v[20:23], v[212:215]
    s_waitcnt lgkmcnt(4)
    v_mfma_f32_16x16x32_bf16 v[212:215], v[72:75], v[20:23], v[212:215]
    s_waitcnt lgkmcnt(2)
    v_mfma_f32_16x16x32_bf16 v[216:219], v[76:79], v[20:23], v[216:219]
    s_waitcnt lgkmcnt(0)
    v_mfma_f32_16x16x32_bf16 v[212:215], v[80:83], v[20:23], v[212:215]
    s_waitcnt vmcnt(12)
    s_barrier
    s_cmp_lg_u32 s26, 0
    s_cbranch_scc1 nf_9
    s_mov_b64 exec, 1
    s_cmp_lg_u32 s84, 1
    s_cbranch_scc1 sl_10
    buffer_store_dwordx2 v[242:243], v244, s[40:43], s97 offen
    s_mov_b64 exec, -1
    s_branch nf_9
sl_10:
    buffer_wbl2 sc1
    s_waitcnt vmcnt(0)
    buffer_store_dwordx2 v[242:243], v244, s[40:43], s97 offen sc1
    s_mov_b64 exec, -1
nf_9:
    s_mov_b32 s96, 0
pl_11:
    buffer_load_dwordx2 v[18:19], v239, s[40:43], s66 offen sc1
    s_waitcnt vmcnt(0)
    v_cmp_ne_u64 vcc, s[94:95], v[18:19]
    s_add_u32 s96, s96, 1
    s_cbranch_vccz pd_12
    s_cmp_lt_u32 s96, 40000
    s_cbranch_scc1 pl_11
pd_12:
    buffer_load_dwordx4 v[144:147], v2, s[40:43], s54 offen offset:0 sc1
    buffer_load_dwordx4 v[148:151], v2, s[40:43], s55 offen offset:0 sc1
    buffer_load_dwordx4 v[152:155], v2, s[40:43], s54 offen offset:1024 sc1
    buffer_load_dwordx4 v[156:159], v2, s[40:43], s55 offen offset:1024 sc1
    buffer_load_dwordx4 v[160:163], v2, s[40:43], s54 offen offset:2048 sc1
    buffer_load_dwordx4 v[164:167], v2, s[40:43], s55 offen offset:2048 sc1
    buffer_load_dwordx4 v[168:171], v2, s[40:43], s54 offen offset:3072 sc1
    s_add_u32 s54, s54, 4096
    buffer_load_dwordx4 v[172:175], v2, s[40:43], s55 offen offset:3072 sc1
    s_add_u32 s55, s55, 4096
    buffer_load_dwordx4 v[176:179], v2, s[40:43], s54 offen offset:0 sc1
    buffer_load_dwordx4 v[180:183], v2, s[40:43], s55 offen offset:0 sc1
    ds_read_b64_tr_b16 v[84:85], v220 offset:36864
    ds_read_b64_tr_b16 v[86:87], v220 offset:39936
    ds_read_b64_tr_b16 v[88:89], v221 offset:36864
    ds_read_b64_tr_b16 v[90:91], v221 offset:39936
    ds_read_b64_tr_b16 v[92:93], v220 offset:43008
    ds_read_b64_tr_b16 v[94:95], v220 offset:46080
    ds_read_b64_tr_b16 v[48:49], v220 offset:49152
    ds_read_b64_tr_b16 v[50:51], v220 offset:52224
    ds_read_b64_tr_b16 v[52:53], v221 offset:49152
    ds_read_b64_tr_b16 v[54:55], v221 offset:52224
    ds_read_b64_tr_b16 v[56:57], v220 offset:55296
    ds_read_b64_tr_b16 v[58:59], v220 offset:58368
    ds_read_b64_tr_b16 v[60:61], v222 offset:0
    ds_read_b64_tr_b16 v[62:63], v222 offset:3072
    s_waitcnt lgkmcnt(12)
    v_mfma_f32_16x16x32_bf16 v[212:215], v[84:87], v[20:23], v[212:215]
    ds_read_b64_tr_b16 v[64:65], v223 offset:0
    ds_read_b64_tr_b16 v[66:67], v223 offset:3072
    s_waitcnt lgkmcnt(12)
    v_mfma_f32_16x16x32_bf16 v[216:219], v[88:91], v[20:23], v[216:219]
    ds_read_b64_tr_b16 v[68:69], v222 offset:6144
    ds_read_b64_tr_b16 v[70:71], v222 offset:9216
    s_waitcnt lgkmcnt(12)
    v_mfma_f32_16x16x32_bf16 v[212:215], v[92:95], v[20:23], v[212:215]
    s_waitcnt lgkmcnt(10)
    v_mfma_f32_16x16x32_bf16 v[212:215], v[48:51], v[20:23], v[212:215]
    s_waitcnt lgkmcnt(8)
    v_mfma_f32_16x16x32_bf16 v[216:219], v[52:55], v[20:23], v[216:219]
    s_waitcnt lgkmcnt(6)
    v_mfma_f32_16x16x32_bf16 v[212:215], v[56:59], v[20:23], v[212:215]
    s_waitcnt lgkmcnt(4)
    v_mfma_f32_16x16x32_bf16 v[212:215], v[60:63], v[20:23], v[212:215]
    s_waitcnt lgkmcnt(2)
    v_mfma_f32_16x16x32_bf16 v[216:219], v[64:67], v[20:23], v[216:219]
    s_waitcnt lgkmcnt(0)
    v_mfma_f32_16x16x32_bf16 v[212:215], v[68:71], v[20:23], v[212:215]
    v_lshlrev_b32 v200, 16, v120
    v_and_b32 v201, 0xffff0000, v120
    v_lshlrev_b32 v202, 16, v121
    v_and_b32 v203, 0xffff0000, v121
    v_lshlrev_b32 v204, 16, v122
    v_and_b32 v205, 0xffff0000, v122
    v_lshlrev_b32 v206, 16, v123
    v_and_b32 v207, 0xffff0000, v123
    v_lshlrev_b32 v208, 16, v124
    v_and_b32 v209, 0xffff0000, v124
    v_lshlrev_b32 v210, 16, v125
    v_and_b32 v211, 0xffff0000, v125
    v_lshlrev_b32 v224, 16, v126
    v_and_b32 v225, 0xffff0000, v126
    v_lshlrev_b32 v226, 16, v127
    v_and_b32 v227, 0xffff0000, v127
    v_lshlrev_b32 v228, 16, v128
    v_and_b32 v229, 0xffff0000, v128
    v_lshlrev_b32 v230, 16, v129
    v_and_b32 v231, 0xffff0000, v129
    v_lshlrev_b32 v232, 16, v130
    v_and_b32 v233, 0xffff0000, v130
    v_lshlrev_b32 v234, 16, v131
    v_and_b32 v235, 0xffff0000, v131
    ds_read_b64_tr_b16 v[96:97], v12 offset:0
    ds_read_b64_tr_b16 v[98:99], v12 offset:3072
    ds_read_b64_tr_b16 v[100:101], v16 offset:32
    ds_read_b64_tr_b16 v[102:103], v16 offset:3104
    ds_read_b64_tr_b16 v[104:105], v12 offset:64
    ds_read_b64_tr_b16 v[106:107], v12 offset:3136
    ds_read_b64_tr_b16 v[108:109], v16 offset:96
    ds_read_b64_tr_b16 v[110:111], v16 offset:3168
    ds_read_b64_tr_b16 v[112:113], v12 offset:128
    ds_read_b64_tr_b16 v[114:115], v12 offset:3200
    ds_read_b64_tr_b16 v[116:117], v16 offset:160
    ds_read_b64_tr_b16 v[118:119], v16 offset:3232
    s_waitcnt vmcnt(8)
    s_waitcnt lgkmcnt(6)
    v_mfma_f32_16x16x32_bf16 v[48:51], v[96:99], v[144:147], 0
    ds_read_b64_tr_b16 v[120:121], v12 offset:6144
    ds_read_b64_tr_b16 v[122:123], v12 offset:9216
    v_mfma_f32_16x16x32_bf16 v[52:55], v[96:99], v[148:151], 0
    ds_read_b64_tr_b16 v[124:125], v16 offset:6176
    ds_read_b64_tr_b16 v[126:127], v16 offset:9248
    v_mfma_f32_16x16x32_bf16 v[56:59], v[100:103], v[144:147], 0
    ds_read_b64_tr_b16 v[128:129], v12 offset:6208
    ds_read_b64_tr_b16 v[130:131], v12 offset:9280
    v_mfma_f32_16x16x32_bf16 v[60:63], v[100:103], v[148:151], 0
    ds_read_b64_tr_b16 v[132:133], v16 offset:6240
    ds_read_b64_tr_b16 v[134:135], v16 offset:9312
    v_mfma_f32_16x16x32_bf16 v[64:67], v[104:107], v[144:147], 0
    ds_read_b64_tr_b16 v[136:137], v12 offset:6272
    ds_read_b64_tr_b16 v[138:139], v12 offset:9344
    v_mfma_f32_16x16x32_bf16 v[68:71], v[104:107], v[148:151], 0
    ds_read_b64_tr_b16 v[140:141], v16 offset:6304
    s_waitcnt lgkmcnt(11)
    v_mfma_f32_16x16x32_bf16 v[72:75], v[108:111], v[144:147], 0
    ds_read_b64_tr_b16 v[142:143], v16 offset:9376
    v_mfma_f32_16x16x32_bf16 v[76:79], v[108:111], v[148:151], 0
    buffer_load_dwordx4 v[184:187], v2, s[40:43], s54 offen offset:1024 sc1
    v_mfma_f32_16x16x32_bf16 v[80:83], v[112:115], v[144:147], 0
    buffer_load_dwordx2 v[24:25], v6, s[40:43], s52 offen offset:0 sc1
    v_mfma_f32_16x16x32_bf16 v[84:87], v[112:115], v[148:151], 0
    buffer_load_dwordx2 v[26:27], v6, s[40:43], s53 offen offset:0 sc1
    v_mfma_f32_16x16x32_bf16 v[88:91], v[116:119], v[144:147], 0
    v_mfma_f32_16x16x32_bf16 v[92:95], v[116:119], v[148:151], 0
    s_waitcnt vmcnt(9)
    s_waitcnt lgkmcnt(6)
    v_mfma_f32_16x16x32_bf16 v[48:51], v[120:123], v[152:155], v[48:51]
    ds_read_b64_tr_b16 v[96:97], v12 offset:12288
    ds_read_b64_tr_b16 v[98:99], v12 offset:15360
    v_mfma_f32_16x16x32_bf16 v[52:55], v[120:123], v[156:159], v[52:55]
    ds_read_b64_tr_b16 v[100:101], v16 offset:12320
    ds_read_b64_tr_b16 v[102:103], v16 offset:15392
    v_mfma_f32_16x16x32_bf16 v[56:59], v[124:127], v[152:155], v[56:59]
    ds_read_b64_tr_b16 v[104:105], v12 offset:12352
    ds_read_b64_tr_b16 v[106:107], v12 offset:15424
    v_mfma_f32_16x16x32_bf16 v[60:63], v[124:127], v[156:159], v[60:63]
    ds_read_b64_tr_b16 v[108:109], v16 offset:12384
    ds_read_b64_tr_b16 v[110:111], v16 offset:15456
    v_mfma_f32_16x16x32_bf16 v[64:67], v[128:131], v[152:155], v[64:67]
    ds_read_b64_tr_b16 v[112:113], v12 offset:12416
    ds_read_b64_tr_b16 v[114:115], v12 offset:15488
    v_mfma_f32_16x16x32_bf16 v[68:71], v[128:131], v[156:159], v[68:71]
    ds_read_b64_tr_b16 v[116:117], v16 offset:12448
    s_waitcnt lgkmcnt(11)
    v_mfma_f32_16x16x32_bf16 v[72:75], v[132:135], v[152:155], v[72:75]
    ds_read_b64_tr_b16 v[118:119], v16 offset:15520
    v_mfma_f32_16x16x32_bf16 v[76:79], v[132:135], v[156:159], v[76:79]
    buffer_load_dwordx4 v[188:191], v2, s[40:43], s55 offen offset:1024 sc1
    v_mfma_f32_16x16x32_bf16 v[80:83], v[136:139], v[152:155], v[80:83]
    buffer_load_dwordx4 v[144:147], v2, s[40:43], s54 offen offset:2048 sc1
    v_mfma_f32_16x16x32_bf16 v[84:87], v[136:139], v[156:159], v[84:87]
    buffer_load_dwordx2 v[28:29], v6, s[40:43], s52 offen offset:128 sc1
    v_mfma_f32_16x16x32_bf16 v[88:91], v[140:143], v[152:155], v[88:91]
    buffer_load_dwordx2 v[30:31], v6, s[40:43], s53 offen offset:128 sc1
    v_mfma_f32_16x16x32_bf16 v[92:95], v[140:143], v[156:159], v[92:95]
    s_waitcnt vmcnt(11)
    s_waitcnt lgkmcnt(6)
    v_mfma_f32_16x16x32_bf16 v[48:51], v[96:99], v[160:163], v[48:51]
    ds_read_b64_tr_b16 v[120:121], v12 offset:18432
    ds_read_b64_tr_b16 v[122:123], v12 offset:21504
    v_mfma_f32_16x16x32_bf16 v[52:55], v[96:99], v[164:167], v[52:55]
    ds_read_b64_tr_b16 v[124:125], v16 offset:18464
    ds_read_b64_tr_b16 v[126:127], v16 offset:21536
    v_mfma_f32_16x16x32_bf16 v[56:59], v[100:103], v[160:163], v[56:59]
    ds_read_b64_tr_b16 v[128:129], v12 offset:18496
    ds_read_b64_tr_b16 v[130:131], v12 offset:21568
    v_mfma_f32_16x16x32_bf16 v[60:63], v[100:103], v[164:167], v[60:63]
    ds_read_b64_tr_b16 v[132:133], v16 offset:18528
    ds_read_b64_tr_b16 v[134:135], v16 offset:21600
    v_mfma_f32_16x16x32_bf16 v[64:67], v[104:107], v[160:163], v[64:67]
    ds_read_b64_tr_b16 v[136:137], v12 offset:18560
    ds_read_b64_tr_b16 v[138:139], v12 offset:21632
    v_mfma_f32_16x16x32_bf16 v[68:71], v[104:107], v[164:167], v[68:71]
    ds_read_b64_tr_b16 v[140:141], v16 offset:18592
    s_waitcnt lgkmcnt(11)
    v_mfma_f32_16x16x32_bf16 v[72:75], v[108:111], v[160:163], v[72:75]
    ds_read_b64_tr_b16 v[142:143], v16 offset:21664
    v_mfma_f32_16x16x32_bf16 v[76:79], v[108:111], v[164:167], v[76:79]
    buffer_load_dwordx4 v[148:151], v2, s[40:43], s55 offen offset:2048 sc1
    v_mfma_f32_16x16x32_bf16 v[80:83], v[112:115], v[160:163], v[80:83]
    buffer_load_dwordx4 v[152:155], v2, s[40:43], s54 offen offset:3072 sc1
    v_mfma_f32_16x16x32_bf16 v[84:87], v[112:115], v[164:167], v[84:87]
    s_add_u32 s54, s54, 4096
    s_add_u32 m0, s81, 73728
    v_mfma_f32_16x16x32_bf16 v[88:91], v[116:119], v[160:163], v[88:91]
    s_add_u32 s80, s80, 393216
    v_mfma_f32_16x16x32_bf16 v[92:95], v[116:119], v[164:167], v[92:95]
    buffer_load_dwordx4 v192, s[36:39], s80 offen lds
    s_waitcnt vmcnt(12)
    s_waitcnt lgkmcnt(6)
    v_mfma_f32_16x16x32_bf16 v[48:51], v[120:123], v[168:171], v[48:51]
    ds_read_b64_tr_b16 v[96:97], v12 offset:24576
    ds_read_b64_tr_b16 v[98:99], v12 offset:27648
    v_mfma_f32_16x16x32_bf16 v[52:55], v[120:123], v[172:175], v[52:55]
    ds_read_b64_tr_b16 v[100:101], v16 offset:24608
    ds_read_b64_tr_b16 v[102:103], v16 offset:27680
    v_mfma_f32_16x16x32_bf16 v[56:59], v[124:127], v[168:171], v[56:59]
    ds_read_b64_tr_b16 v[104:105], v12 offset:24640
    ds_read_b64_tr_b16 v[106:107], v12 offset:27712
    v_mfma_f32_16x16x32_bf16 v[60:63], v[124:127], v[172:175], v[60:63]
    ds_read_b64_tr_b16 v[108:109], v16 offset:24672
    ds_read_b64_tr_b16 v[110:111], v16 offset:27744
    v_mfma_f32_16x16x32_bf16 v[64:67], v[128:131], v[168:171], v[64:67]
    ds_read_b64_tr_b16 v[112:113], v12 offset:24704
    ds_read_b64_tr_b16 v[114:115], v12 offset:27776
    v_mfma_f32_16x16x32_bf16 v[68:71], v[128:131], v[172:175], v[68:71]
    ds_read_b64_tr_b16 v[116:117], v16 offset:24736
    s_waitcnt lgkmcnt(11)
    v_mfma_f32_16x16x32_bf16 v[72:75], v[132:135], v[168:171], v[72:75]
    ds_read_b64_tr_b16 v[118:119], v16 offset:27808
    s_add_u32 m0, s81, 74752
    v_mfma_f32_16x16x32_bf16 v[76:79], v[132:135], v[172:175], v[76:79]
    s_nop 0
    s_waitcnt vmcnt(3)
    v_mfma_f32_16x16x32_bf16 v[80:83], v[136:139], v[168:171], v[80:83]
    buffer_load_dwordx4 v193, s[36:39], s80 offen lds
    v_mfma_f32_16x16x32_bf16 v[84:87], v[136:139], v[172:175], v[84:87]
    buffer_load_dwordx4 v[156:159], v2, s[40:43], s55 offen offset:3072 sc1
    v_mfma_f32_16x16x32_bf16 v[88:91], v[140:143], v[168:171], v[88:91]
    s_add_u32 s55, s55, 4096
    v_add_f32 v24, v24, v26
    v_mfma_f32_16x16x32_bf16 v[92:95], v[140:143], v[172:175], v[92:95]
    buffer_load_dwordx4 v[160:163], v2, s[40:43], s54 offen offset:0 sc1
    s_waitcnt lgkmcnt(6)
    v_mfma_f32_16x16x32_bf16 v[48:51], v[96:99], v[176:179], v[48:51]
    ds_read_b64_tr_b16 v[120:121], v12 offset:30720
    ds_read_b64_tr_b16 v[122:123], v12 offset:33792
    v_mfma_f32_16x16x32_bf16 v[52:55], v[96:99], v[180:183], v[52:55]
    ds_read_b64_tr_b16 v[124:125], v16 offset:30752
    ds_read_b64_tr_b16 v[126:127], v16 offset:33824
    v_mfma_f32_16x16x32_bf16 v[56:59], v[100:103], v[176:179], v[56:59]
    ds_read_b64_tr_b16 v[128:129], v12 offset:30784
    ds_read_b64_tr_b16 v[130:131], v12 offset:33856
    v_mfma_f32_16x16x32_bf16 v[60:63], v[100:103], v[180:183], v[60:63]
    ds_read_b64_tr_b16 v[132:133], v16 offset:30816
    ds_read_b64_tr_b16 v[134:135], v16 offset:33888
    v_mfma_f32_16x16x32_bf16 v[64:67], v[104:107], v[176:179], v[64:67]
    ds_read_b64_tr_b16 v[136:137], v12 offset:30848
    ds_read_b64_tr_b16 v[138:139], v12 offset:33920
    v_mfma_f32_16x16x32_bf16 v[68:71], v[104:107], v[180:183], v[68:71]
    ds_read_b64_tr_b16 v[140:141], v16 offset:30880
    s_waitcnt lgkmcnt(11)
    v_mfma_f32_16x16x32_bf16 v[72:75], v[108:111], v[176:179], v[72:75]
    ds_read_b64_tr_b16 v[142:143], v16 offset:33952
    s_add_u32 m0, s81, 75776
    v_mfma_f32_16x16x32_bf16 v[76:79], v[108:111], v[180:183], v[76:79]
    s_nop 0
    v_add_f32 v25, v25, v27
    v_mfma_f32_16x16x32_bf16 v[80:83], v[112:115], v[176:179], v[80:83]
    buffer_load_dwordx4 v194, s[36:39], s80 offen lds
    v_mfma_f32_16x16x32_bf16 v[84:87], v[112:115], v[180:183], v[84:87]
    s_add_u32 m0, s81, 76800
    s_nop 0
    v_mfma_f32_16x16x32_bf16 v[88:91], v[116:119], v[176:179], v[88:91]
    buffer_load_dwordx4 v195, s[36:39], s80 offen lds
    v_mfma_f32_16x16x32_bf16 v[92:95], v[116:119], v[180:183], v[92:95]
    buffer_load_dwordx4 v[164:167], v2, s[40:43], s55 offen offset:0 sc1
    s_waitcnt lgkmcnt(6)
    v_mfma_f32_16x16x32_bf16 v[48:51], v[120:123], v[184:187], v[48:51]
    ds_read_b64_tr_b16 v[96:97], v12 offset:36864
    ds_read_b64_tr_b16 v[98:99], v12 offset:39936
    v_mfma_f32_16x16x32_bf16 v[52:55], v[120:123], v[188:191], v[52:55]
    ds_read_b64_tr_b16 v[100:101], v16 offset:36896
    ds_read_b64_tr_b16 v[102:103], v16 offset:39968
    v_mfma_f32_16x16x32_bf16 v[56:59], v[124:127], v[184:187], v[56:59]
    ds_read_b64_tr_b16 v[104:105], v12 offset:36928
    ds_read_b64_tr_b16 v[106:107], v12 offset:40000
    v_mfma_f32_16x16x32_bf16 v[60:63], v[124:127], v[188:191], v[60:63]
    ds_read_b64_tr_b16 v[108:109], v16 offset:36960
    ds_read_b64_tr_b16 v[110:111], v16 offset:40032
    v_mfma_f32_16x16x32_bf16 v[64:67], v[128:131], v[184:187], v[64:67]
    ds_read_b64_tr_b16 v[112:113], v12 offset:36992
    ds_read_b64_tr_b16 v[114:115], v12 offset:40064
    v_mfma_f32_16x16x32_bf16 v[68:71], v[128:131], v[188:191], v[68:71]
    ds_read_b64_tr_b16 v[116:117], v16 offset:37024
    s_waitcnt lgkmcnt(11)
    v_mfma_f32_16x16x32_bf16 v[72:75], v[132:135], v[184:187], v[72:75]
    ds_read_b64_tr_b16 v[118:119], v16 offset:40096
    v_add_f32 v28, v28, v30
    v_mfma_f32_16x16x32_bf16 v[76:79], v[132:135], v[188:191], v[76:79]
    buffer_load_dwordx4 v[168:171], v2, s[40:43], s54 offen offset:1024 sc1
    v_mfma_f32_16x16x32_bf16 v[80:83], v[136:139], v[184:187], v[80:83]
    s_add_u32 m0, s81, 77824
    s_nop 0
    v_mfma_f32_16x16x32_bf16 v[84:87], v[136:139], v[188:191], v[84:87]
    buffer_load_dwordx4 v196, s[36:39], s80 offen lds
    v_mfma_f32_16x16x32_bf16 v[88:91], v[140:143], v[184:187], v[88:91]
    s_add_u32 m0, s81, 78848
    s_nop 0
    v_mfma_f32_16x16x32_bf16 v[92:95], v[140:143], v[188:191], v[92:95]
    buffer_load_dwordx4 v197, s[36:39], s80 offen lds
    s_waitcnt vmcnt(11)
    s_waitcnt lgkmcnt(6)
    v_mfma_f32_16x16x32_bf16 v[48:51], v[96:99], v[144:147], v[48:51]
    ds_read_b64_tr_b16 v[120:121], v12 offset:43008
    ds_read_b64_tr_b16 v[122:123], v12 offset:46080
    v_mfma_f32_16x16x32_bf16 v[52:55], v[96:99], v[148:151], v[52:55]
    ds_read_b64_tr_b16 v[124:125], v16 offset:43040
    ds_read_b64_tr_b16 v[126:127], v16 offset:46112
    v_mfma_f32_16x16x32_bf16 v[56:59], v[100:103], v[144:147], v[56:59]
    ds_read_b64_tr_b16 v[128:129], v12 offset:43072
    ds_read_b64_tr_b16 v[130:131], v12 offset:46144
    v_mfma_f32_16x16x32_bf16 v[60:63], v[100:103], v[148:151], v[60:63]
    ds_read_b64_tr_b16 v[132:133], v16 offset:43104
    ds_read_b64_tr_b16 v[134:135], v16 offset:46176
    v_mfma_f32_16x16x32_bf16 v[64:67], v[104:107], v[144:147], v[64:67]
    ds_read_b64_tr_b16 v[136:137], v12 offset:43136
    ds_read_b64_tr_b16 v[138:139], v12 offset:46208
    v_mfma_f32_16x16x32_bf16 v[68:71], v[104:107], v[148:151], v[68:71]
    ds_read_b64_tr_b16 v[140:141], v16 offset:43168
    s_waitcnt lgkmcnt(11)
    v_mfma_f32_16x16x32_bf16 v[72:75], v[108:111], v[144:147], v[72:75]
    ds_read_b64_tr_b16 v[142:143], v16 offset:46240
    v_add_f32 v29, v29, v31
    v_mfma_f32_16x16x32_bf16 v[76:79], v[108:111], v[148:151], v[76:79]
    buffer_load_dwordx4 v[172:175], v2, s[40:43], s55 offen offset:1024 sc1
    v_mfma_f32_16x16x32_bf16 v[80:83], v[112:115], v[144:147], v[80:83]
    buffer_load_dwordx4 v[176:179], v2, s[40:43], s54 offen offset:2048 sc1
    v_mfma_f32_16x16x32_bf16 v[84:87], v[112:115], v[148:151], v[84:87]
    s_add_u32 m0, s81, 98304
    s_add_u32 s80, s80, 393216
    v_mfma_f32_16x16x32_bf16 v[88:91], v[116:119], v[144:147], v[88:91]
    buffer_load_dwordx4 v192, s[36:39], s80 offen lds
    v_mfma_f32_16x16x32_bf16 v[92:95], v[116:119], v[148:151], v[92:95]
    s_add_u32 m0, s81, 99328
    s_waitcnt vmcnt(10)
    s_waitcnt lgkmcnt(6)
    v_mfma_f32_16x16x32_bf16 v[48:51], v[120:123], v[152:155], v[48:51]
    ds_read_b64_tr_b16 v[96:97], v12 offset:49152
    ds_read_b64_tr_b16 v[98:99], v12 offset:52224
    v_mfma_f32_16x16x32_bf16 v[52:55], v[120:123], v[156:159], v[52:55]
    ds_read_b64_tr_b16 v[100:101], v16 offset:49184
    ds_read_b64_tr_b16 v[102:103], v16 offset:52256
    v_mfma_f32_16x16x32_bf16 v[56:59], v[124:127], v[152:155], v[56:59]
    ds_read_b64_tr_b16 v[104:105], v12 offset:49216
    ds_read_b64_tr_b16 v[106:107], v12 offset:52288
    v_mfma_f32_16x16x32_bf16 v[60:63], v[124:127], v[156:159], v[60:63]
    ds_read_b64_tr_b16 v[108:109], v16 offset:49248
    ds_read_b64_tr_b16 v[110:111], v16 offset:52320
    v_mfma_f32_16x16x32_bf16 v[64:67], v[128:131], v[152:155], v[64:67]
    ds_read_b64_tr_b16 v[112:113], v12 offset:49280
    ds_read_b64_tr_b16 v[114:115], v12 offset:52352
    v_mfma_f32_16x16x32_bf16 v[68:71], v[128:131], v[156:159], v[68:71]
    ds_read_b64_tr_b16 v[116:117], v16 offset:49312
    s_waitcnt lgkmcnt(11)
    v_mfma_f32_16x16x32_bf16 v[72:75], v[132:135], v[152:155], v[72:75]
    ds_read_b64_tr_b16 v[118:119], v16 offset:52384
    s_nop 0
    v_mfma_f32_16x16x32_bf16 v[76:79], v[132:135], v[156:159], v[76:79]
    buffer_load_dwordx4 v193, s[36:39], s80 offen lds
    v_mfma_f32_16x16x32_bf16 v[80:83], v[136:139], v[152:155], v[80:83]
    buffer_load_dwordx4 v[180:183], v2, s[40:43], s55 offen offset:2048 sc1
    v_mfma_f32_16x16x32_bf16 v[84:87], v[136:139], v[156:159], v[84:87]
    buffer_load_dwordx4 v[184:187], v2, s[40:43], s54 offen offset:3072 sc1
    v_mfma_f32_16x16x32_bf16 v[88:91], v[140:143], v[152:155], v[88:91]
    s_add_u32 s54, s54, 4096
    s_add_u32 m0, s81, 100352
    v_mfma_f32_16x16x32_bf16 v[92:95], v[140:143], v[156:159], v[92:95]
    s_nop 0
    s_waitcnt vmcnt(9)
    s_waitcnt lgkmcnt(6)
    v_mfma_f32_16x16x32_bf16 v[48:51], v[96:99], v[160:163], v[48:51]
    ds_read_b64_tr_b16 v[120:121], v12 offset:55296
    ds_read_b64_tr_b16 v[122:123], v12 offset:58368
    v_mfma_f32_16x16x32_bf16 v[52:55], v[96:99], v[164:167], v[52:55]
    ds_read_b64_tr_b16 v[124:125], v16 offset:55328
    ds_read_b64_tr_b16 v[126:127], v16 offset:58400
    v_mfma_f32_16x16x32_bf16 v[56:59], v[100:103], v[160:163], v[56:59]
    ds_read_b64_tr_b16 v[128:129], v12 offset:55360
    ds_read_b64_tr_b16 v[130:131], v12 offset:58432
    v_mfma_f32_16x16x32_bf16 v[60:63], v[100:103], v[164:167], v[60:63]
    ds_read_b64_tr_b16 v[132:133], v16 offset:55392
    ds_read_b64_tr_b16 v[134:135], v16 offset:58464
    v_mfma_f32_16x16x32_bf16 v[64:67], v[104:107], v[160:163], v[64:67]
    ds_read_b64_tr_b16 v[136:137], v12 offset:55424
    ds_read_b64_tr_b16 v[138:139], v12 offset:58496
    v_mfma_f32_16x16x32_bf16 v[68:71], v[104:107], v[164:167], v[68:71]
    ds_read_b64_tr_b16 v[140:141], v16 offset:55456
    s_waitcnt lgkmcnt(11)
    v_mfma_f32_16x16x32_bf16 v[72:75], v[108:111], v[160:163], v[72:75]
    ds_read_b64_tr_b16 v[142:143], v16 offset:58528
    v_mov_b32 v26, v24
    v_mfma_f32_16x16x32_bf16 v[76:79], v[108:111], v[164:167], v[76:79]
    buffer_load_dwordx4 v194, s[36:39], s80 offen lds
    v_mfma_f32_16x16x32_bf16 v[80:83], v[112:115], v[160:163], v[80:83]
    buffer_load_dwordx4 v[188:191], v2, s[40:43], s55 offen offset:3072 sc1
    v_mfma_f32_16x16x32_bf16 v[84:87], v[112:115], v[164:167], v[84:87]
    s_add_u32 s55, s55, 4096
    v_mov_b32 v27, v25
    v_mfma_f32_16x16x32_bf16 v[88:91], v[116:119], v[160:163], v[88:91]
    buffer_load_dwordx4 v[144:147], v2, s[40:43], s54 offen offset:0 sc1
    v_mfma_f32_16x16x32_bf16 v[92:95], v[116:119], v[164:167], v[92:95]
    s_add_u32 m0, s81, 101376
    s_waitcnt vmcnt(8)
    s_waitcnt lgkmcnt(6)
    v_mfma_f32_16x16x32_bf16 v[48:51], v[120:123], v[168:171], v[48:51]
    ds_read_b64_tr_b16 v[96:97], v17 offset:0
    ds_read_b64_tr_b16 v[98:99], v17 offset:3072
    v_mfma_f32_16x16x32_bf16 v[52:55], v[120:123], v[172:175], v[52:55]
    ds_read_b64_tr_b16 v[100:101], v9 offset:32
    ds_read_b64_tr_b16 v[102:103], v9 offset:3104
    v_mfma_f32_16x16x32_bf16 v[56:59], v[124:127], v[168:171], v[56:59]
    ds_read_b64_tr_b16 v[104:105], v17 offset:64
    ds_read_b64_tr_b16 v[106:107], v17 offset:3136
    v_mfma_f32_16x16x32_bf16 v[60:63], v[124:127], v[172:175], v[60:63]
    ds_read_b64_tr_b16 v[108:109], v9 offset:96
    ds_read_b64_tr_b16 v[110:111], v9 offset:3168
    v_mfma_f32_16x16x32_bf16 v[64:67], v[128:131], v[168:171], v[64:67]
    ds_read_b64_tr_b16 v[112:113], v17 offset:128
    ds_read_b64_tr_b16 v[114:115], v17 offset:3200
    v_mfma_f32_16x16x32_bf16 v[68:71], v[128:131], v[172:175], v[68:71]
    ds_read_b64_tr_b16 v[116:117], v9 offset:160
    s_waitcnt lgkmcnt(11)
    v_mfma_f32_16x16x32_bf16 v[72:75], v[132:135], v[168:171], v[72:75]
    ds_read_b64_tr_b16 v[118:119], v9 offset:3232
    s_nop 0
    v_mfma_f32_16x16x32_bf16 v[76:79], v[132:135], v[172:175], v[76:79]
    buffer_load_dwordx4 v195, s[36:39], s80 offen lds
    v_mfma_f32_16x16x32_bf16 v[80:83], v[136:139], v[168:171], v[80:83]
    buffer_load_dwordx4 v[148:151], v2, s[40:43], s55 offen offset:0 sc1
    v_mfma_f32_16x16x32_bf16 v[84:87], v[136:139], v[172:175], v[84:87]
    buffer_load_dwordx4 v[152:155], v2, s[40:43], s54 offen offset:1024 sc1
    v_mfma_f32_16x16x32_bf16 v[88:91], v[140:143], v[168:171], v[88:91]
    s_add_u32 m0, s81, 102400
    s_nop 0
    v_mfma_f32_16x16x32_bf16 v[92:95], v[140:143], v[172:175], v[92:95]
    buffer_load_dwordx4 v196, s[36:39], s80 offen lds
    s_waitcnt vmcnt(8)
    s_waitcnt lgkmcnt(6)
    v_mfma_f32_16x16x32_bf16 v[48:51], v[96:99], v[176:179], v[48:51]
    ds_read_b64_tr_b16 v[120:121], v17 offset:6144
    ds_read_b64_tr_b16 v[122:123], v17 offset:9216
    v_mfma_f32_16x16x32_bf16 v[52:55], v[96:99], v[180:183], v[52:55]
    ds_read_b64_tr_b16 v[124:125], v9 offset:6176
    ds_read_b64_tr_b16 v[126:127], v9 offset:9248
    v_mfma_f32_16x16x32_bf16 v[56:59], v[100:103], v[176:179], v[56:59]
    ds_read_b64_tr_b16 v[128:129], v17 offset:6208
    ds_read_b64_tr_b16 v[130:131], v17 offset:9280
    v_mfma_f32_16x16x32_bf16 v[60:63], v[100:103], v[180:183], v[60:63]
    ds_read_b64_tr_b16 v[132:133], v9 offset:6240
    ds_read_b64_tr_b16 v[134:135], v9 offset:9312
    v_mfma_f32_16x16x32_bf16 v[64:67], v[104:107], v[176:179], v[64:67]
    ds_read_b64_tr_b16 v[136:137], v17 offset:6272
    ds_read_b64_tr_b16 v[138:139], v17 offset:9344
    v_mfma_f32_16x16x32_bf16 v[68:71], v[104:107], v[180:183], v[68:71]
    ds_read_b64_tr_b16 v[140:141], v9 offset:6304
    s_waitcnt lgkmcnt(11)
    v_mfma_f32_16x16x32_bf16 v[72:75], v[108:111], v[176:179], v[72:75]
    ds_read_b64_tr_b16 v[142:143], v9 offset:9376
    v_mov_b32 v30, v28
    v_mfma_f32_16x16x32_bf16 v[76:79], v[108:111], v[180:183], v[76:79]
    buffer_load_dwordx4 v[156:159], v2, s[40:43], s55 offen offset:1024 sc1
    v_mfma_f32_16x16x32_bf16 v[80:83], v[112:115], v[176:179], v[80:83]
    buffer_load_dwordx4 v[160:163], v2, s[40:43], s54 offen offset:2048 sc1
    v_mfma_f32_16x16x32_bf16 v[84:87], v[112:115], v[180:183], v[84:87]
    s_add_u32 m0, s81, 103424
    s_nop 0
    v_mfma_f32_16x16x32_bf16 v[88:91], v[116:119], v[176:179], v[88:91]
    buffer_load_dwordx4 v197, s[36:39], s80 offen lds
    v_mfma_f32_16x16x32_bf16 v[92:95], v[116:119], v[180:183], v[92:95]
    buffer_load_dwordx4 v[164:167], v2, s[40:43], s55 offen offset:2048 sc1
    s_waitcnt vmcnt(1)
    s_barrier
    s_waitcnt lgkmcnt(6)
    v_mfma_f32_16x16x32_bf16 v[48:51], v[120:123], v[184:187], v[48:51]
    ds_read_b64_tr_b16 v[96:97], v17 offset:12288
    ds_read_b64_tr_b16 v[98:99], v17 offset:15360
    v_mfma_f32_16x16x32_bf16 v[52:55], v[120:123], v[188:191], v[52:55]
    ds_read_b64_tr_b16 v[100:101], v9 offset:12320
    ds_read_b64_tr_b16 v[102:103], v9 offset:15392
    v_mfma_f32_16x16x32_bf16 v[56:59], v[124:127], v[184:187], v[56:59]
    ds_read_b64_tr_b16 v[104:105], v17 offset:12352
    ds_read_b64_tr_b16 v[106:107], v17 offset:15424
    v_mfma_f32_16x16x32_bf16 v[60:63], v[124:127], v[188:191], v[60:63]
    ds_read_b64_tr_b16 v[108:109], v9 offset:12384
    ds_read_b64_tr_b16 v[110:111], v9 offset:15456
    v_mfma_f32_16x16x32_bf16 v[64:67], v[128:131], v[184:187], v[64:67]
    ds_read_b64_tr_b16 v[112:113], v17 offset:12416
    ds_read_b64_tr_b16 v[114:115], v17 offset:15488
    v_mfma_f32_16x16x32_bf16 v[68:71], v[128:131], v[188:191], v[68:71]
    ds_read_b64_tr_b16 v[116:117], v9 offset:12448
    s_waitcnt lgkmcnt(11)
    v_mfma_f32_16x16x32_bf16 v[72:75], v[132:135], v[184:187], v[72:75]
    ds_read_b64_tr_b16 v[118:119], v9 offset:15520
    ds_read_b64_tr_b16 v[36:37], v222 offset:12288
    v_mfma_f32_16x16x32_bf16 v[76:79], v[132:135], v[188:191], v[76:79]
    ds_read_b64_tr_b16 v[38:39], v222 offset:15360
    ds_read_b64_tr_b16 v[40:41], v223 offset:12288
    v_mfma_f32_16x16x32_bf16 v[80:83], v[136:139], v[184:187], v[80:83]
    ds_read_b64_tr_b16 v[42:43], v223 offset:15360
    v_mov_b32 v31, v29
    v_mfma_f32_16x16x32_bf16 v[84:87], v[136:139], v[188:191], v[84:87]
    buffer_load_dwordx4 v[168:171], v2, s[40:43], s54 offen offset:3072 sc1
    v_mfma_f32_16x16x32_bf16 v[88:91], v[140:143], v[184:187], v[88:91]
    s_add_u32 s54, s54, 4096
    v_permlane16_swap_b32 v26, v24
    v_mfma_f32_16x16x32_bf16 v[92:95], v[140:143], v[188:191], v[92:95]
    buffer_load_dwordx4 a[144:147], v2, s[40:43], s57 offen offset:3072 sc1
    s_waitcnt lgkmcnt(10)
    v_mfma_f32_16x16x32_bf16 v[48:51], v[96:99], v[144:147], v[48:51]
    ds_read_b64_tr_b16 v[120:121], v17 offset:18432
    ds_read_b64_tr_b16 v[122:123], v17 offset:21504
    v_mfma_f32_16x16x32_bf16 v[52:55], v[96:99], v[148:151], v[52:55]
    ds_read_b64_tr_b16 v[124:125], v9 offset:18464
    ds_read_b64_tr_b16 v[126:127], v9 offset:21536
    v_mfma_f32_16x16x32_bf16 v[56:59], v[100:103], v[144:147], v[56:59]
    ds_read_b64_tr_b16 v[128:129], v17 offset:18496
    ds_read_b64_tr_b16 v[130:131], v17 offset:21568
    v_mfma_f32_16x16x32_bf16 v[60:63], v[100:103], v[148:151], v[60:63]
    ds_read_b64_tr_b16 v[132:133], v9 offset:18528
    ds_read_b64_tr_b16 v[134:135], v9 offset:21600
    v_mfma_f32_16x16x32_bf16 v[64:67], v[104:107], v[144:147], v[64:67]
    ds_read_b64_tr_b16 v[136:137], v17 offset:18560
    ds_read_b64_tr_b16 v[138:139], v17 offset:21632
    v_mfma_f32_16x16x32_bf16 v[68:71], v[104:107], v[148:151], v[68:71]
    ds_read_b64_tr_b16 v[140:141], v9 offset:18592
    s_waitcnt lgkmcnt(15)
    s_waitcnt lgkmcnt(11)
    v_mfma_f32_16x16x32_bf16 v[212:215], v[36:39], v[20:23], v[212:215]
    ds_read_b64_tr_b16 v[142:143], v9 offset:21664
    ds_read_b64_tr_b16 v[44:45], v222 offset:18432
    v_mfma_f32_16x16x32_bf16 v[216:219], v[40:43], v[20:23], v[216:219]
    ds_read_b64_tr_b16 v[46:47], v222 offset:21504
    ds_read_b64_tr_b16 v[32:33], v222 offset:24576
    v_mfma_f32_16x16x32_bf16 v[72:75], v[108:111], v[144:147], v[72:75]
    ds_read_b64_tr_b16 v[34:35], v222 offset:27648
    s_add_u32 s57, s57, 4096
    v_mfma_f32_16x16x32_bf16 v[76:79], v[108:111], v[148:151], v[76:79]
    buffer_load_dwordx4 v[172:175], v2, s[40:43], s55 offen offset:3072 sc1
    v_mfma_f32_16x16x32_bf16 v[80:83], v[112:115], v[144:147], v[80:83]
    s_add_u32 s55, s55, 4096
    v_permlane16_swap_b32 v27, v25
    v_mfma_f32_16x16x32_bf16 v[84:87], v[112:115], v[148:151], v[84:87]
    buffer_load_dwordx4 v[176:179], v2, s[40:43], s54 offen offset:0 sc1
    v_mfma_f32_16x16x32_bf16 v[88:91], v[116:119], v[144:147], v[88:91]
    buffer_load_dwordx4 a[148:151], v2, s[40:43], s57 offen offset:0 sc1
    v_mfma_f32_16x16x32_bf16 v[92:95], v[116:119], v[148:151], v[92:95]
    buffer_load_dwordx4 v[180:183], v2, s[40:43], s55 offen offset:0 sc1
    s_waitcnt lgkmcnt(10)
    v_mfma_f32_16x16x32_bf16 v[48:51], v[120:123], v[152:155], v[48:51]
    ds_read_b64_tr_b16 v[96:97], v17 offset:24576
    ds_read_b64_tr_b16 v[98:99], v17 offset:27648
    v_mfma_f32_16x16x32_bf16 v[52:55], v[120:123], v[156:159], v[52:55]
    ds_read_b64_tr_b16 v[100:101], v9 offset:24608
    ds_read_b64_tr_b16 v[102:103], v9 offset:27680
    v_mfma_f32_16x16x32_bf16 v[56:59], v[124:127], v[152:155], v[56:59]
    ds_read_b64_tr_b16 v[104:105], v17 offset:24640
    ds_read_b64_tr_b16 v[106:107], v17 offset:27712
    v_mfma_f32_16x16x32_bf16 v[60:63], v[124:127], v[156:159], v[60:63]
    ds_read_b64_tr_b16 v[108:109], v9 offset:24672
    ds_read_b64_tr_b16 v[110:111], v9 offset:27744
    v_mfma_f32_16x16x32_bf16 v[64:67], v[128:131], v[152:155], v[64:67]
    ds_read_b64_tr_b16 v[112:113], v17 offset:24704
    ds_read_b64_tr_b16 v[114:115], v17 offset:27776
    v_mfma_f32_16x16x32_bf16 v[68:71], v[128:131], v[156:159], v[68:71]
    ds_read_b64_tr_b16 v[116:117], v9 offset:24736
    s_waitcnt lgkmcnt(15)
    s_waitcnt lgkmcnt(11)
    v_mfma_f32_16x16x32_bf16 v[212:215], v[44:47], v[20:23], v[212:215]
    ds_read_b64_tr_b16 v[118:119], v9 offset:27808
    ds_read_b64_tr_b16 v[36:37], v223 offset:24576
    v_mfma_f32_16x16x32_bf16 v[212:215], v[32:35], v[20:23], v[212:215]
    ds_read_b64_tr_b16 v[38:39], v223 offset:27648
    ds_read_b64_tr_b16 v[40:41], v222 offset:30720
    v_mfma_f32_16x16x32_bf16 v[72:75], v[132:135], v[152:155], v[72:75]
    ds_read_b64_tr_b16 v[42:43], v222 offset:33792
    v_permlane16_swap_b32 v30, v28
    v_mfma_f32_16x16x32_bf16 v[76:79], v[132:135], v[156:159], v[76:79]
    buffer_load_dwordx4 v[184:187], v2, s[40:43], s54 offen offset:1024 sc1
    v_mfma_f32_16x16x32_bf16 v[80:83], v[136:139], v[152:155], v[80:83]
    buffer_load_dwordx4 a[152:155], v2, s[40:43], s57 offen offset:1024 sc1
    v_mfma_f32_16x16x32_bf16 v[84:87], v[136:139], v[156:159], v[84:87]
    buffer_load_dwordx4 v[188:191], v2, s[40:43], s55 offen offset:1024 sc1
    v_mfma_f32_16x16x32_bf16 v[88:91], v[140:143], v[152:155], v[88:91]
    buffer_load_dwordx4 v[144:147], v2, s[40:43], s54 offen offset:2048 sc1
    v_mfma_f32_16x16x32_bf16 v[92:95], v[140:143], v[156:159], v[92:95]
    buffer_load_dwordx4 a[156:159], v2, s[40:43], s57 offen offset:2048 sc1
    s_waitcnt vmcnt(11)
    s_waitcnt lgkmcnt(10)
    v_mfma_f32_16x16x32_bf16 v[48:51], v[96:99], v[160:163], v[48:51]
    ds_read_b64_tr_b16 v[120:121], v17 offset:30720
    ds_read_b64_tr_b16 v[122:123], v17 offset:33792
    v_mfma_f32_16x16x32_bf16 v[52:55], v[96:99], v[164:167], v[52:55]
    ds_read_b64_tr_b16 v[124:125], v9 offset:30752
    ds_read_b64_tr_b16 v[126:127], v9 offset:33824
    v_mfma_f32_16x16x32_bf16 v[56:59], v[100:103], v[160:163], v[56:59]
    ds_read_b64_tr_b16 v[128:129], v17 offset:30784
    ds_read_b64_tr_b16 v[130:131], v17 offset:33856
    v_mfma_f32_16x16x32_bf16 v[60:63], v[100:103], v[164:167], v[60:63]
    ds_read_b64_tr_b16 v[132:133], v9 offset:30816
    ds_read_b64_tr_b16 v[134:135], v9 offset:33888
    v_mfma_f32_16x16x32_bf16 v[64:67], v[104:107], v[160:163], v[64:67]
    ds_read_b64_tr_b16 v[136:137], v17 offset:30848
    ds_read_b64_tr_b16 v[138:139], v17 offset:33920
    v_mfma_f32_16x16x32_bf16 v[68:71], v[104:107], v[164:167], v[68:71]
    ds_read_b64_tr_b16 v[140:141], v9 offset:30880
    s_waitcnt lgkmcnt(15)
    s_waitcnt lgkmcnt(11)
    v_mfma_f32_16x16x32_bf16 v[216:219], v[36:39], v[20:23], v[216:219]
    ds_read_b64_tr_b16 v[142:143], v9 offset:33952
    ds_read_b64_tr_b16 v[44:45], v222 offset:36864
    v_mfma_f32_16x16x32_bf16 v[212:215], v[40:43], v[20:23], v[212:215]
    ds_read_b64_tr_b16 v[46:47], v222 offset:39936
    ds_read_b64_tr_b16 v[32:33], v223 offset:36864
    v_mfma_f32_16x16x32_bf16 v[72:75], v[108:111], v[160:163], v[72:75]
    ds_read_b64_tr_b16 v[34:35], v223 offset:39936
    v_permlane16_swap_b32 v31, v29
    v_mfma_f32_16x16x32_bf16 v[76:79], v[108:111], v[164:167], v[76:79]
    buffer_load_dwordx4 v[148:151], v2, s[40:43], s55 offen offset:2048 sc1
    v_mfma_f32_16x16x32_bf16 v[80:83], v[112:115], v[160:163], v[80:83]
    buffer_load_dwordx4 v[152:155], v2, s[40:43], s54 offen offset:3072 sc1
    v_mfma_f32_16x16x32_bf16 v[84:87], v[112:115], v[164:167], v[84:87]
    buffer_load_dwordx4 a[160:163], v2, s[40:43], s57 offen offset:3072 sc1
    v_mfma_f32_16x16x32_bf16 v[88:91], v[116:119], v[160:163], v[88:91]
    s_add_u32 s57, s57, 4096
    v_add_f32 v24, v24, v26
    v_mfma_f32_16x16x32_bf16 v[92:95], v[116:119], v[164:167], v[92:95]
    v_add_f32 v25, v25, v27
    s_waitcnt vmcnt(11)
    s_waitcnt lgkmcnt(10)
    v_mfma_f32_16x16x32_bf16 v[48:51], v[120:123], v[168:171], v[48:51]
    ds_read_b64_tr_b16 v[96:97], v17 offset:36864
    ds_read_b64_tr_b16 v[98:99], v17 offset:39936
    v_mfma_f32_16x16x32_bf16 v[52:55], v[120:123], v[172:175], v[52:55]
    ds_read_b64_tr_b16 v[100:101], v9 offset:36896
    ds_read_b64_tr_b16 v[102:103], v9 offset:39968
    v_mfma_f32_16x16x32_bf16 v[56:59], v[124:127], v[168:171], v[56:59]
    ds_read_b64_tr_b16 v[104:105], v17 offset:36928
    ds_read_b64_tr_b16 v[106:107], v17 offset:40000
    v_mfma_f32_16x16x32_bf16 v[60:63], v[124:127], v[172:175], v[60:63]
    ds_read_b64_tr_b16 v[108:109], v9 offset:36960
    ds_read_b64_tr_b16 v[110:111], v9 offset:40032
    v_mfma_f32_16x16x32_bf16 v[64:67], v[128:131], v[168:171], v[64:67]
    ds_read_b64_tr_b16 v[112:113], v17 offset:36992
    ds_read_b64_tr_b16 v[114:115], v17 offset:40064
    v_mfma_f32_16x16x32_bf16 v[68:71], v[128:131], v[172:175], v[68:71]
    ds_read_b64_tr_b16 v[116:117], v9 offset:37024
    s_waitcnt lgkmcnt(15)
    s_waitcnt lgkmcnt(11)
    v_mfma_f32_16x16x32_bf16 v[212:215], v[44:47], v[20:23], v[212:215]
    ds_read_b64_tr_b16 v[118:119], v9 offset:40096
    ds_read_b64_tr_b16 v[36:37], v222 offset:43008
    v_mfma_f32_16x16x32_bf16 v[216:219], v[32:35], v[20:23], v[216:219]
    ds_read_b64_tr_b16 v[38:39], v222 offset:46080
    ds_read_b64_tr_b16 v[40:41], v222 offset:49152
    v_mfma_f32_16x16x32_bf16 v[72:75], v[132:135], v[168:171], v[72:75]
    ds_read_b64_tr_b16 v[42:43], v222 offset:52224
    v_add_f32 v28, v28, v30
    v_mfma_f32_16x16x32_bf16 v[76:79], v[132:135], v[172:175], v[76:79]
    buffer_load_dwordx4 v[156:159], v2, s[40:43], s55 offen offset:3072 sc1
    v_mfma_f32_16x16x32_bf16 v[80:83], v[136:139], v[168:171], v[80:83]
    buffer_load_dwordx4 a[164:167], v2, s[40:43], s57 offen offset:0 sc1
    v_mfma_f32_16x16x32_bf16 v[84:87], v[136:139], v[172:175], v[84:87]
    v_add_f32 v29, v29, v31
    v_mov_b32 v26, v24
    v_mfma_f32_16x16x32_bf16 v[88:91], v[140:143], v[168:171], v[88:91]
    v_mov_b32 v27, v25
    v_mov_b32 v30, v28
    v_mfma_f32_16x16x32_bf16 v[92:95], v[140:143], v[172:175], v[92:95]
    v_mov_b32 v31, v29
    s_waitcnt vmcnt(10)
    s_waitcnt lgkmcnt(10)
    v_mfma_f32_16x16x32_bf16 v[48:51], v[96:99], v[176:179], v[48:51]
    ds_read_b64_tr_b16 v[120:121], v17 offset:43008
    ds_read_b64_tr_b16 v[122:123], v17 offset:46080
    v_mfma_f32_16x16x32_bf16 v[52:55], v[96:99], v[180:183], v[52:55]
    ds_read_b64_tr_b16 v[124:125], v9 offset:43040
    ds_read_b64_tr_b16 v[126:127], v9 offset:46112
    v_mfma_f32_16x16x32_bf16 v[56:59], v[100:103], v[176:179], v[56:59]
    ds_read_b64_tr_b16 v[128:129], v17 offset:43072
    ds_read_b64_tr_b16 v[130:131], v17 offset:46144
    v_mfma_f32_16x16x32_bf16 v[60:63], v[100:103], v[180:183], v[60:63]
    ds_read_b64_tr_b16 v[132:133], v9 offset:43104
    ds_read_b64_tr_b16 v[134:135], v9 offset:46176
    v_mfma_f32_16x16x32_bf16 v[64:67], v[104:107], v[176:179], v[64:67]
    ds_read_b64_tr_b16 v[136:137], v17 offset:43136
    ds_read_b64_tr_b16 v[138:139], v17 offset:46208
    v_mfma_f32_16x16x32_bf16 v[68:71], v[104:107], v[180:183], v[68:71]
    ds_read_b64_tr_b16 v[140:141], v9 offset:43168
    s_waitcnt lgkmcnt(15)
    s_waitcnt lgkmcnt(11)
    v_mfma_f32_16x16x32_bf16 v[212:215], v[36:39], v[20:23], v[212:215]
    ds_read_b64_tr_b16 v[142:143], v9 offset:46240
    ds_read_b64_tr_b16 v[44:45], v223 offset:49152
    v_mfma_f32_16x16x32_bf16 v[212:215], v[40:43], v[20:23], v[212:215]
    ds_read_b64_tr_b16 v[46:47], v223 offset:52224
    ds_read_b64_tr_b16 v[32:33], v222 offset:55296
    v_mfma_f32_16x16x32_bf16 v[72:75], v[108:111], v[176:179], v[72:75]
    ds_read_b64_tr_b16 v[34:35], v222 offset:58368
    v_permlane32_swap_b32 v26, v24
    v_mfma_f32_16x16x32_bf16 v[76:79], v[108:111], v[180:183], v[76:79]
    buffer_load_dwordx4 a[168:171], v2, s[40:43], s57 offen offset:1024 sc1
    v_mfma_f32_16x16x32_bf16 v[80:83], v[112:115], v[176:179], v[80:83]
    v_permlane32_swap_b32 v27, v25
    v_permlane32_swap_b32 v30, v28
    v_mfma_f32_16x16x32_bf16 v[84:87], v[112:115], v[180:183], v[84:87]
    v_permlane32_swap_b32 v31, v29
    v_add_f32 v24, v24, v26
    v_mfma_f32_16x16x32_bf16 v[88:91], v[116:119], v[176:179], v[88:91]
    v_add_f32 v25, v25, v27
    v_add_f32 v28, v28, v30
    v_mfma_f32_16x16x32_bf16 v[92:95], v[116:119], v[180:183], v[92:95]
    v_add_f32 v29, v29, v31
    s_waitcnt vmcnt(8)
    s_waitcnt lgkmcnt(10)
    v_mfma_f32_16x16x32_bf16 v[48:51], v[120:123], v[184:187], v[48:51]
    ds_read_b64_tr_b16 v[96:97], v17 offset:49152
    ds_read_b64_tr_b16 v[98:99], v17 offset:52224
    v_mfma_f32_16x16x32_bf16 v[52:55], v[120:123], v[188:191], v[52:55]
    ds_read_b64_tr_b16 v[100:101], v9 offset:49184
    ds_read_b64_tr_b16 v[102:103], v9 offset:52256
    v_mfma_f32_16x16x32_bf16 v[56:59], v[124:127], v[184:187], v[56:59]
    ds_read_b64_tr_b16 v[104:105], v17 offset:49216
    ds_read_b64_tr_b16 v[106:107], v17 offset:52288
    v_mfma_f32_16x16x32_bf16 v[60:63], v[124:127], v[188:191], v[60:63]
    ds_read_b64_tr_b16 v[108:109], v9 offset:49248
    ds_read_b64_tr_b16 v[110:111], v9 offset:52320
    v_mfma_f32_16x16x32_bf16 v[64:67], v[128:131], v[184:187], v[64:67]
    ds_read_b64_tr_b16 v[112:113], v17 offset:49280
    ds_read_b64_tr_b16 v[114:115], v17 offset:52352
    v_mfma_f32_16x16x32_bf16 v[68:71], v[128:131], v[188:191], v[68:71]
    ds_read_b64_tr_b16 v[116:117], v9 offset:49312
    s_waitcnt lgkmcnt(15)
    s_waitcnt lgkmcnt(11)
    v_mfma_f32_16x16x32_bf16 v[216:219], v[44:47], v[20:23], v[216:219]
    ds_read_b64_tr_b16 v[118:119], v9 offset:52384
    v_mul_f32 v24, s93, v24
    v_mfma_f32_16x16x32_bf16 v[212:215], v[32:35], v[20:23], v[212:215]
    v_mul_f32 v28, s93, v28
    v_mul_f32 v26, v24, v24
    v_mfma_f32_16x16x32_bf16 v[72:75], v[132:135], v[184:187], v[72:75]
    v_mul_f32 v30, v28, v28
    v_fma_f32 v25, v25, s93, -v26
    v_mfma_f32_16x16x32_bf16 v[76:79], v[132:135], v[188:191], v[76:79]
    v_fma_f32 v29, v29, s93, -v30
    v_max_f32 v25, 0, v25
    v_mfma_f32_16x16x32_bf16 v[80:83], v[136:139], v[184:187], v[80:83]
    v_max_f32 v29, 0, v29
    v_cvt_pk_bf16_f32 v25, v25, v25
    v_mfma_f32_16x16x32_bf16 v[84:87], v[136:139], v[188:191], v[84:87]
    v_cvt_pk_bf16_f32 v29, v29, v29
    v_cvt_pk_bf16_f32 v24, v24, v24
    v_mfma_f32_16x16x32_bf16 v[88:91], v[140:143], v[184:187], v[88:91]
    v_cvt_pk_bf16_f32 v28, v28, v28
    v_and_b32 v25, 0xffff0000, v25
    v_mfma_f32_16x16x32_bf16 v[92:95], v[140:143], v[188:191], v[92:95]
    v_and_b32 v29, 0xffff0000, v29
    s_waitcnt vmcnt(5)
    s_waitcnt lgkmcnt(6)
    v_mfma_f32_16x16x32_bf16 v[48:51], v[96:99], v[144:147], v[48:51]
    ds_read_b64_tr_b16 v[120:121], v17 offset:55296
    ds_read_b64_tr_b16 v[122:123], v17 offset:58368
    v_mfma_f32_16x16x32_bf16 v[52:55], v[96:99], v[148:151], v[52:55]
    ds_read_b64_tr_b16 v[124:125], v9 offset:55328
    ds_read_b64_tr_b16 v[126:127], v9 offset:58400
    v_mfma_f32_16x16x32_bf16 v[56:59], v[100:103], v[144:147], v[56:59]
    ds_read_b64_tr_b16 v[128:129], v17 offset:55360
    ds_read_b64_tr_b16 v[130:131], v17 offset:58432
    v_mfma_f32_16x16x32_bf16 v[60:63], v[100:103], v[148:151], v[60:63]
    ds_read_b64_tr_b16 v[132:133], v9 offset:55392
    ds_read_b64_tr_b16 v[134:135], v9 offset:58464
    v_mfma_f32_16x16x32_bf16 v[64:67], v[104:107], v[144:147], v[64:67]
    ds_read_b64_tr_b16 v[136:137], v17 offset:55424
    ds_read_b64_tr_b16 v[138:139], v17 offset:58496
    v_mfma_f32_16x16x32_bf16 v[68:71], v[104:107], v[148:151], v[68:71]
    ds_read_b64_tr_b16 v[140:141], v9 offset:55456
    s_waitcnt lgkmcnt(11)
    v_mfma_f32_16x16x32_bf16 v[72:75], v[108:111], v[144:147], v[72:75]
    ds_read_b64_tr_b16 v[142:143], v9 offset:58528
    v_mfma_f32_16x16x32_bf16 v[76:79], v[108:111], v[148:151], v[76:79]
    s_mov_b32 exec_lo, 0x00010001
    s_mov_b32 exec_hi, 0x00010001
    ds_write_b128 v8, v[212:215]
    ds_write_b128 v8, v[216:219] offset:64
    s_mov_b64 exec, -1
    v_mfma_f32_16x16x32_bf16 v[80:83], v[112:115], v[144:147], v[80:83]
    v_and_b32 v24, 0xffff0000, v24
    v_and_b32 v28, 0xffff0000, v28
    v_mfma_f32_16x16x32_bf16 v[84:87], v[112:115], v[148:151], v[84:87]
    v_add_f32 v25, 0x3727c5ac, v25
    v_add_f32 v29, 0x3727c5ac, v29
    v_mfma_f32_16x16x32_bf16 v[88:91], v[116:119], v[144:147], v[88:91]
    v_xor_b32 v24, 0x80000000, v24
    v_xor_b32 v28, 0x80000000, v28
    v_mfma_f32_16x16x32_bf16 v[92:95], v[116:119], v[148:151], v[92:95]
    v_cvt_pk_bf16_f32 v25, v25, v25
    s_waitcnt lgkmcnt(0)
    s_barrier
    s_waitcnt vmcnt(2)
    v_mfma_f32_16x16x32_bf16 v[48:51], v[120:123], v[152:155], v[48:51]
    ds_read_b128 v[96:99], v14 offset:0
    v_cvt_pk_bf16_f32 v29, v29, v29
    v_mfma_f32_16x16x32_bf16 v[52:55], v[120:123], v[156:159], v[52:55]
    ds_read_b128 v[100:103], v14 offset:64
    v_and_b32 v25, 0xffff0000, v25
    v_mfma_f32_16x16x32_bf16 v[56:59], v[124:127], v[152:155], v[56:59]
    ds_read_b128 v[104:107], v14 offset:128
    v_and_b32 v29, 0xffff0000, v29
    v_mfma_f32_16x16x32_bf16 v[60:63], v[124:127], v[156:159], v[60:63]
    ds_read_b128 v[108:111], v14 offset:256
    v_sqrt_f32 v25, v25
    v_mfma_f32_16x16x32_bf16 v[64:67], v[128:131], v[152:155], v[64:67]
    ds_read_b128 v[112:115], v14 offset:320
    v_sqrt_f32 v29, v29
    v_mfma_f32_16x16x32_bf16 v[68:71], v[128:131], v[156:159], v[68:71]
    ds_read_b128 v[116:119], v14 offset:384
    v_mfma_f32_16x16x32_bf16 v[72:75], v[132:135], v[152:155], v[72:75]
    ds_read_b128 v[212:215], v14 offset:192
    v_cvt_pk_bf16_f32 v25, v25, v25
    v_mfma_f32_16x16x32_bf16 v[76:79], v[132:135], v[156:159], v[76:79]
    ds_read_b128 v[216:219], v14 offset:448
    v_cvt_pk_bf16_f32 v29, v29, v29
    v_mfma_f32_16x16x32_bf16 v[80:83], v[136:139], v[152:155], v[80:83]
    v_and_b32 v25, 0xffff0000, v25
    v_and_b32 v29, 0xffff0000, v29
    v_mfma_f32_16x16x32_bf16 v[84:87], v[136:139], v[156:159], v[84:87]
    v_rcp_f32 v25, v25
    v_rcp_f32 v29, v29
    v_mfma_f32_16x16x32_bf16 v[88:91], v[140:143], v[152:155], v[88:91]
    v_mul_f32 v24, v24, v25
    v_mov_b32 v26, v25
    v_mfma_f32_16x16x32_bf16 v[92:95], v[140:143], v[156:159], v[92:95]
    v_mul_f32 v28, v28, v29
    v_mov_b32 v30, v29
    s_waitcnt lgkmcnt(0)
    v_pk_add_f32 v[100:101], v[100:101], v[212:213]
    v_pk_add_f32 v[112:113], v[112:113], v[216:217]
    v_pk_add_f32 v[102:103], v[102:103], v[214:215]
    v_pk_add_f32 v[114:115], v[114:115], v[218:219]
    buffer_load_dwordx4 a[172:175], v2, s[40:43], s57 offen offset:2048 sc1
    buffer_load_dwordx4 a[176:179], v2, s[40:43], s57 offen offset:3072 sc1
    s_add_u32 s57, s57, 4096
    buffer_load_dwordx4 a[180:183], v2, s[40:43], s57 offen offset:0 sc1
    buffer_load_dwordx4 a[184:187], v2, s[40:43], s57 offen offset:1024 sc1
    buffer_load_dwordx4 a[188:191], v2, s[40:43], s57 offen offset:2048 sc1
    buffer_load_dwordx4 a[192:195], v2, s[40:43], s57 offen offset:3072 sc1
    s_add_u32 s57, s57, 4096
    buffer_load_dwordx4 a[196:199], v2, s[40:43], s57 offen offset:0 sc1
    buffer_load_dwordx4 a[200:203], v2, s[40:43], s57 offen offset:1024 sc1
    buffer_load_dwordx4 a[204:207], v2, s[40:43], s57 offen offset:2048 sc1
    buffer_load_dwordx4 a[208:211], v2, s[40:43], s57 offen offset:3072 sc1
    s_add_u32 s57, s57, 4096
    v_pk_fma_f32 v[168:169], v[96:97], v[24:25], v[200:201] op_sel_hi:[1,0,1]
    v_pk_fma_f32 v[170:171], v[98:99], v[24:25], v[202:203] op_sel_hi:[1,0,1]
    v_pk_fma_f32 v[172:173], v[96:97], v[28:29], v[200:201] op_sel_hi:[1,0,1]
    v_pk_fma_f32 v[174:175], v[98:99], v[28:29], v[202:203] op_sel_hi:[1,0,1]
    v_pk_fma_f32 v[168:169], v[48:49], v[26:27], v[168:169] op_sel_hi:[1,0,1]
    v_pk_fma_f32 v[170:171], v[50:51], v[26:27], v[170:171] op_sel_hi:[1,0,1]
    v_pk_fma_f32 v[172:173], v[52:53], v[30:31], v[172:173] op_sel_hi:[1,0,1]
    v_pk_fma_f32 v[174:175], v[54:55], v[30:31], v[174:175] op_sel_hi:[1,0,1]
    v_max_f32 v168, 0, v168
    v_max_f32 v169, 0, v169
    v_max_f32 v170, 0, v170
    v_max_f32 v171, 0, v171
    v_max_f32 v172, 0, v172
    v_max_f32 v173, 0, v173
    v_max_f32 v174, 0, v174
    v_max_f32 v175, 0, v175
    v_pk_mul_f32 v[168:169], v[168:169], v[168:169]
    v_pk_mul_f32 v[170:171], v[170:171], v[170:171]
    v_pk_mul_f32 v[172:173], v[172:173], v[172:173]
    v_pk_mul_f32 v[174:175], v[174:175], v[174:175]
    v_cvt_pk_bf16_f32 v144, v168, v169
    v_cvt_pk_bf16_f32 v145, v170, v171
    v_cvt_pk_bf16_f32 v146, v172, v173
    v_cvt_pk_bf16_f32 v147, v174, v175
    s_nop 0
    v_permlane16_swap_b32 v144, v146
    v_permlane16_swap_b32 v145, v147
    buffer_store_dwordx4 v[144:147], v238, s[40:43], s6 offen offset:0 sc1
    v_pk_fma_f32 v[168:169], v[100:101], v[24:25], v[204:205] op_sel_hi:[1,0,1]
    v_pk_fma_f32 v[170:171], v[102:103], v[24:25], v[206:207] op_sel_hi:[1,0,1]
    v_pk_fma_f32 v[172:173], v[100:101], v[28:29], v[204:205] op_sel_hi:[1,0,1]
    v_pk_fma_f32 v[174:175], v[102:103], v[28:29], v[206:207] op_sel_hi:[1,0,1]
    v_pk_fma_f32 v[168:169], v[56:57], v[26:27], v[168:169] op_sel_hi:[1,0,1]
    v_pk_fma_f32 v[170:171], v[58:59], v[26:27], v[170:171] op_sel_hi:[1,0,1]
    v_pk_fma_f32 v[172:173], v[60:61], v[30:31], v[172:173] op_sel_hi:[1,0,1]
    v_pk_fma_f32 v[174:175], v[62:63], v[30:31], v[174:175] op_sel_hi:[1,0,1]
    v_max_f32 v168, 0, v168
    v_max_f32 v169, 0, v169
    v_max_f32 v170, 0, v170
    v_max_f32 v171, 0, v171
    v_max_f32 v172, 0, v172
    v_max_f32 v173, 0, v173
    v_max_f32 v174, 0, v174
    v_max_f32 v175, 0, v175
    v_pk_mul_f32 v[168:169], v[168:169], v[168:169]
    v_pk_mul_f32 v[170:171], v[170:171], v[170:171]
    v_pk_mul_f32 v[172:173], v[172:173], v[172:173]
    v_pk_mul_f32 v[174:175], v[174:175], v[174:175]
    v_cvt_pk_bf16_f32 v148, v168, v169
    v_cvt_pk_bf16_f32 v149, v170, v171
    v_cvt_pk_bf16_f32 v150, v172, v173
    v_cvt_pk_bf16_f32 v151, v174, v175
    s_nop 0
    v_permlane16_swap_b32 v148, v150
    v_permlane16_swap_b32 v149, v151
    buffer_store_dwordx4 v[148:151], v238, s[40:43], s6 offen offset:512 sc1
    v_pk_fma_f32 v[168:169], v[104:105], v[24:25], v[208:209] op_sel_hi:[1,0,1]
    v_pk_fma_f32 v[170:171], v[106:107], v[24:25], v[210:211] op_sel_hi:[1,0,1]
    v_pk_fma_f32 v[172:173], v[104:105], v[28:29], v[208:209] op_sel_hi:[1,0,1]
    v_pk_fma_f32 v[174:175], v[106:107], v[28:29], v[210:211] op_sel_hi:[1,0,1]
    v_pk_fma_f32 v[168:169], v[64:65], v[26:27], v[168:169] op_sel_hi:[1,0,1]
    v_pk_fma_f32 v[170:171], v[66:67], v[26:27], v[170:171] op_sel_hi:[1,0,1]
    v_pk_fma_f32 v[172:173], v[68:69], v[30:31], v[172:173] op_sel_hi:[1,0,1]
    v_pk_fma_f32 v[174:175], v[70:71], v[30:31], v[174:175] op_sel_hi:[1,0,1]
    v_max_f32 v168, 0, v168
    v_max_f32 v169, 0, v169
    v_max_f32 v170, 0, v170
    v_max_f32 v171, 0, v171
    v_max_f32 v172, 0, v172
    v_max_f32 v173, 0, v173
    v_max_f32 v174, 0, v174
    v_max_f32 v175, 0, v175
    v_pk_mul_f32 v[168:169], v[168:169], v[168:169]
    v_pk_mul_f32 v[170:171], v[170:171], v[170:171]
    v_pk_mul_f32 v[172:173], v[172:173], v[172:173]
    v_pk_mul_f32 v[174:175], v[174:175], v[174:175]
    v_cvt_pk_bf16_f32 v152, v168, v169
    v_cvt_pk_bf16_f32 v153, v170, v171
    v_cvt_pk_bf16_f32 v154, v172, v173
    v_cvt_pk_bf16_f32 v155, v174, v175
    s_nop 0
    v_permlane16_swap_b32 v152, v154
    v_permlane16_swap_b32 v153, v155
    buffer_store_dwordx4 v[152:155], v238, s[40:43], s6 offen offset:1024 sc1
    v_pk_fma_f32 v[168:169], v[108:109], v[24:25], v[224:225] op_sel_hi:[1,0,1]
    v_pk_fma_f32 v[170:171], v[110:111], v[24:25], v[226:227] op_sel_hi:[1,0,1]
    v_pk_fma_f32 v[172:173], v[108:109], v[28:29], v[224:225] op_sel_hi:[1,0,1]
    v_pk_fma_f32 v[174:175], v[110:111], v[28:29], v[226:227] op_sel_hi:[1,0,1]
    v_pk_fma_f32 v[168:169], v[72:73], v[26:27], v[168:169] op_sel_hi:[1,0,1]
    v_pk_fma_f32 v[170:171], v[74:75], v[26:27], v[170:171] op_sel_hi:[1,0,1]
    v_pk_fma_f32 v[172:173], v[76:77], v[30:31], v[172:173] op_sel_hi:[1,0,1]
    v_pk_fma_f32 v[174:175], v[78:79], v[30:31], v[174:175] op_sel_hi:[1,0,1]
    v_max_f32 v168, 0, v168
    v_max_f32 v169, 0, v169
    v_max_f32 v170, 0, v170
    v_max_f32 v171, 0, v171
    v_max_f32 v172, 0, v172
    v_max_f32 v173, 0, v173
    v_max_f32 v174, 0, v174
    v_max_f32 v175, 0, v175
    v_pk_mul_f32 v[168:169], v[168:169], v[168:169]
    v_pk_mul_f32 v[170:171], v[170:171], v[170:171]
    v_pk_mul_f32 v[172:173], v[172:173], v[172:173]
    v_pk_mul_f32 v[174:175], v[174:175], v[174:175]
    v_cvt_pk_bf16_f32 v156, v168, v169
    v_cvt_pk_bf16_f32 v157, v170, v171
    v_cvt_pk_bf16_f32 v158, v172, v173
    v_cvt_pk_bf16_f32 v159, v174, v175
    s_nop 0
    v_permlane16_swap_b32 v156, v158
    v_permlane16_swap_b32 v157, v159
    buffer_store_dwordx4 v[156:159], v238, s[40:43], s6 offen offset:1536 sc1
    v_pk_fma_f32 v[168:169], v[112:113], v[24:25], v[228:229] op_sel_hi:[1,0,1]
    v_pk_fma_f32 v[170:171], v[114:115], v[24:25], v[230:231] op_sel_hi:[1,0,1]
    v_pk_fma_f32 v[172:173], v[112:113], v[28:29], v[228:229] op_sel_hi:[1,0,1]
    v_pk_fma_f32 v[174:175], v[114:115], v[28:29], v[230:231] op_sel_hi:[1,0,1]
    v_pk_fma_f32 v[168:169], v[80:81], v[26:27], v[168:169] op_sel_hi:[1,0,1]
    v_pk_fma_f32 v[170:171], v[82:83], v[26:27], v[170:171] op_sel_hi:[1,0,1]
    v_pk_fma_f32 v[172:173], v[84:85], v[30:31], v[172:173] op_sel_hi:[1,0,1]
    v_pk_fma_f32 v[174:175], v[86:87], v[30:31], v[174:175] op_sel_hi:[1,0,1]
    v_max_f32 v168, 0, v168
    v_max_f32 v169, 0, v169
    v_max_f32 v170, 0, v170
    v_max_f32 v171, 0, v171
    v_max_f32 v172, 0, v172
    v_max_f32 v173, 0, v173
    v_max_f32 v174, 0, v174
    v_max_f32 v175, 0, v175
    v_pk_mul_f32 v[168:169], v[168:169], v[168:169]
    v_pk_mul_f32 v[170:171], v[170:171], v[170:171]
    v_pk_mul_f32 v[172:173], v[172:173], v[172:173]
    v_pk_mul_f32 v[174:175], v[174:175], v[174:175]
    v_cvt_pk_bf16_f32 v160, v168, v169
    v_cvt_pk_bf16_f32 v161, v170, v171
    v_cvt_pk_bf16_f32 v162, v172, v173
    v_cvt_pk_bf16_f32 v163, v174, v175
    s_nop 0
    v_permlane16_swap_b32 v160, v162
    v_permlane16_swap_b32 v161, v163
    buffer_store_dwordx4 v[160:163], v238, s[40:43], s6 offen offset:2048 sc1
    v_pk_fma_f32 v[168:169], v[116:117], v[24:25], v[232:233] op_sel_hi:[1,0,1]
    v_pk_fma_f32 v[170:171], v[118:119], v[24:25], v[234:235] op_sel_hi:[1,0,1]
    v_pk_fma_f32 v[172:173], v[116:117], v[28:29], v[232:233] op_sel_hi:[1,0,1]
    v_pk_fma_f32 v[174:175], v[118:119], v[28:29], v[234:235] op_sel_hi:[1,0,1]
    v_pk_fma_f32 v[168:169], v[88:89], v[26:27], v[168:169] op_sel_hi:[1,0,1]
    v_pk_fma_f32 v[170:171], v[90:91], v[26:27], v[170:171] op_sel_hi:[1,0,1]
    v_pk_fma_f32 v[172:173], v[92:93], v[30:31], v[172:173] op_sel_hi:[1,0,1]
    v_pk_fma_f32 v[174:175], v[94:95], v[30:31], v[174:175] op_sel_hi:[1,0,1]
    v_max_f32 v168, 0, v168
    v_max_f32 v169, 0, v169
    v_max_f32 v170, 0, v170
    v_max_f32 v171, 0, v171
    v_max_f32 v172, 0, v172
    v_max_f32 v173, 0, v173
    v_max_f32 v174, 0, v174
    v_max_f32 v175, 0, v175
    v_pk_mul_f32 v[168:169], v[168:169], v[168:169]
    v_pk_mul_f32 v[170:171], v[170:171], v[170:171]
    v_pk_mul_f32 v[172:173], v[172:173], v[172:173]
    v_pk_mul_f32 v[174:175], v[174:175], v[174:175]
    v_cvt_pk_bf16_f32 v164, v168, v169
    v_cvt_pk_bf16_f32 v165, v170, v171
    v_cvt_pk_bf16_f32 v166, v172, v173
    v_cvt_pk_bf16_f32 v167, v174, v175
    s_nop 0
    v_permlane16_swap_b32 v164, v166
    v_permlane16_swap_b32 v165, v167
    buffer_store_dwordx4 v[164:167], v238, s[40:43], s6 offen offset:2560 sc1
    s_mov_b32 s44, s18
    s_and_b32 s45, s19, 0xffff
    s_mov_b32 s46, 1280
    s_mov_b32 s47, 0x00020000
    s_mov_b32 s36, s20
    s_and_b32 s37, s21, 0xffff
    s_mov_b32 s38, 2621440
    s_mov_b32 s39, 0x00020000
    s_mul_i32 s63, s29, 160
    v_lshlrev_b32 v7, 3, v5
    buffer_load_dwordx2 v[20:21], v7, s[44:47], s63 offen offset:0
    buffer_load_dwordx2 v[22:23], v7, s[44:47], s63 offen offset:32
    buffer_load_dwordx2 v[24:25], v7, s[44:47], s63 offen offset:64
    buffer_load_dwordx2 v[26:27], v7, s[44:47], s63 offen offset:96
    buffer_load_dwordx2 v[28:29], v7, s[44:47], s63 offen offset:128
    s_lshl_b32 s66, s30, 7
    s_add_u32 s66, s66, 16064512
    s_lshl_b32 s97, s31, 3
    s_add_u32 s97, s97, s66
    s_mul_i32 s61, s26, 52
    s_lshl_b32 s62, s28, 2
    s_add_u32 s60, s26, 0
    s_and_b32 s60, s60, 3
    s_mul_i32 s64, s60, 15360
    buffer_load_dwordx4 a[212:215], v2, s[40:43], s57 offen offset:0 sc1
    s_add_u32 s64, s64, 0
    v_add_u32 v11, s64, v2
    s_add_u32 s60, s60, s62
    s_mul_i32 s60, s60, 208
    s_add_u32 s60, s60, s61
    s_lshl_b32 s60, s60, 8
    s_add_u32 s52, s60, 5373952
    s_add_u32 s60, s26, 1
    s_and_b32 s60, s60, 3
    buffer_load_dwordx4 a[216:219], v2, s[40:43], s57 offen offset:1024 sc1
    s_mul_i32 s64, s60, 15360
    s_add_u32 s64, s64, 0
    v_add_u32 v13, s64, v2
    s_add_u32 s60, s60, s62
    s_mul_i32 s60, s60, 208
    s_add_u32 s60, s60, s61
    s_lshl_b32 s60, s60, 8
    s_add_u32 s53, s60, 5373952
    s_add_u32 s60, s26, 2
    buffer_load_dwordx4 a[220:223], v2, s[40:43], s57 offen offset:2048 sc1
    s_and_b32 s60, s60, 3
    s_mul_i32 s64, s60, 15360
    s_add_u32 s64, s64, 5120
    v_add_u32 v14, s64, v2
    s_add_u32 s60, s60, s62
    s_mul_i32 s60, s60, 208
    s_add_u32 s60, s60, s61
    s_lshl_b32 s60, s60, 8
    s_add_u32 s54, s60, 5373952
    buffer_load_dwordx4 a[224:227], v2, s[40:43], s57 offen offset:3072 sc1
    s_add_u32 s57, s57, 4096
    s_add_u32 s60, s26, 3
    s_and_b32 s60, s60, 3
    s_mul_i32 s64, s60, 15360
    s_add_u32 s64, s64, 10240
    v_add_u32 v15, s64, v2
    s_add_u32 s60, s60, s62
    s_mul_i32 s60, s60, 208
    s_add_u32 s60, s60, s61
    s_lshl_b32 s60, s60, 8
    s_add_u32 s55, s60, 5373952
    s_waitcnt vmcnt(9)
    s_barrier
    s_cmp_lg_u32 s26, 0
    s_cbranch_scc1 nf_13
    s_mov_b64 exec, 1
    s_cmp_lg_u32 s84, 1
    s_cbranch_scc1 sl_14
    buffer_store_dwordx2 v[242:243], v244, s[40:43], s97 offen
    s_mov_b64 exec, -1
    s_branch nf_13
sl_14:
    buffer_wbl2 sc1
    s_waitcnt vmcnt(0)
    buffer_store_dwordx2 v[242:243], v244, s[40:43], s97 offen sc1
    s_mov_b64 exec, -1
nf_13:
    buffer_load_dwordx4 a[228:231], v2, s[40:43], s57 offen offset:0 sc1
    buffer_load_dwordx4 a[232:235], v2, s[40:43], s57 offen offset:1024 sc1
    buffer_load_dwordx4 a[236:239], v2, s[40:43], s57 offen offset:2048 sc1
    buffer_load_dwordx4 a[240:243], v2, s[40:43], s57 offen offset:3072 sc1
    s_mov_b32 s96, 0
pl_15:
    buffer_load_dwordx2 v[18:19], v239, s[40:43], s66 offen sc1
    s_waitcnt vmcnt(0)
    v_cmp_ne_u64 vcc, s[94:95], v[18:19]
    s_add_u32 s96, s96, 1
    s_cbranch_vccz pd_16
    s_cmp_lt_u32 s96, 40000
    s_cbranch_scc1 pl_15
pd_16:
    buffer_load_dwordx4 v[120:123], v2, s[40:43], s53 offen offset:0 sc1
    buffer_load_dwordx4 v[124:127], v2, s[40:43], s53 offen offset:1024 sc1
    buffer_load_dwordx4 v[128:131], v2, s[40:43], s53 offen offset:2048 sc1
    buffer_load_dwordx4 v[132:135], v2, s[40:43], s53 offen offset:3072 sc1
    s_add_u32 s53, s53, 4096
    buffer_load_dwordx4 v[136:139], v2, s[40:43], s53 offen offset:0 sc1
    buffer_load_dwordx4 v[140:143], v2, s[40:43], s53 offen offset:1024 sc1
    buffer_load_dwordx4 v[144:147], v2, s[40:43], s53 offen offset:2048 sc1
    buffer_load_dwordx4 v[148:151], v2, s[40:43], s53 offen offset:3072 sc1
    s_add_u32 s53, s53, 4096
    buffer_load_dwordx4 v[152:155], v2, s[40:43], s53 offen offset:0 sc1
    buffer_load_dwordx4 v[156:159], v2, s[40:43], s53 offen offset:1024 sc1
    s_mul_i32 s63, s26, 2816
    s_add_u32 s63, s63, 61440
    v_mul_u32_u24 v9, 176, v4
    v_lshl_add_u32 v9, v5, 3, v9
    v_add_u32 v9, s63, v9
    v_add_u32 v6, 0, v1
    v_mul_u32_u24 v7, 6554, v6
    v_lshrrev_b32 v7, 16, v7
    v_lshlrev_b32 v6, 4, v6
    v_lshl_add_u32 v8, v7, 4, v6
    v_add_u32 v30, s63, v8
    v_mul_u32_u24 v7, 1120, v7
    v_add_u32 v33, v7, v6
    v_add_u32 v6, 64, v1
    v_mul_u32_u24 v7, 6554, v6
    v_lshrrev_b32 v7, 16, v7
    v_lshlrev_b32 v6, 4, v6
    v_lshl_add_u32 v8, v7, 4, v6
    v_add_u32 v31, s63, v8
    v_mul_u32_u24 v7, 1120, v7
    v_add_u32 v34, v7, v6
    v_add_u32 v6, 128, v1
    v_mul_u32_u24 v7, 6554, v6
    v_lshrrev_b32 v7, 16, v7
    v_lshlrev_b32 v6, 4, v6
    v_lshl_add_u32 v8, v7, 4, v6
    v_add_u32 v32, s63, v8
    v_mul_u32_u24 v7, 1120, v7
    v_add_u32 v35, v7, v6
    s_lshl_b32 s58, s28, 6
    s_lshl_b32 s59, s26, 4
    s_add_u32 s58, s58, s59
    s_mul_i32 s58, s58, 1280
    s_mul_i32 s59, s29, 160
    s_add_u32 s58, s58, s59
    v_lshlrev_b32 v36, 16, v246
    v_and_b32 v37, 0xffff0000, v246
    v_lshlrev_b32 v38, 16, v20
    v_and_b32 v39, 0xffff0000, v20
    v_pk_add_f32 v[216:217], v[36:37], v[38:39]
    v_lshlrev_b32 v36, 16, v247
    v_and_b32 v37, 0xffff0000, v247
    v_lshlrev_b32 v38, 16, v21
    v_and_b32 v39, 0xffff0000, v21
    v_pk_add_f32 v[218:219], v[36:37], v[38:39]
    v_lshlrev_b32 v36, 16, v248
    v_and_b32 v37, 0xffff0000, v248
    v_lshlrev_b32 v38, 16, v22
    v_and_b32 v39, 0xffff0000, v22
    v_pk_add_f32 v[220:221], v[36:37], v[38:39]
    v_lshlrev_b32 v36, 16, v249
    v_and_b32 v37, 0xffff0000, v249
    v_lshlrev_b32 v38, 16, v23
    v_and_b32 v39, 0xffff0000, v23
    v_pk_add_f32 v[222:223], v[36:37], v[38:39]
    v_lshlrev_b32 v36, 16, v250
    v_and_b32 v37, 0xffff0000, v250
    v_lshlrev_b32 v38, 16, v24
    v_and_b32 v39, 0xffff0000, v24
    v_pk_add_f32 v[224:225], v[36:37], v[38:39]
    v_lshlrev_b32 v36, 16, v251
    v_and_b32 v37, 0xffff0000, v251
    v_lshlrev_b32 v38, 16, v25
    v_and_b32 v39, 0xffff0000, v25
    v_pk_add_f32 v[226:227], v[36:37], v[38:39]
    v_lshlrev_b32 v36, 16, v252
    v_and_b32 v37, 0xffff0000, v252
    v_lshlrev_b32 v38, 16, v26
    v_and_b32 v39, 0xffff0000, v26
    v_pk_add_f32 v[228:229], v[36:37], v[38:39]
    v_lshlrev_b32 v36, 16, v253
    v_and_b32 v37, 0xffff0000, v253
    v_lshlrev_b32 v38, 16, v27
    v_and_b32 v39, 0xffff0000, v27
    v_pk_add_f32 v[230:231], v[36:37], v[38:39]
    v_lshlrev_b32 v36, 16, v254
    v_and_b32 v37, 0xffff0000, v254
    v_lshlrev_b32 v38, 16, v28
    v_and_b32 v39, 0xffff0000, v28
    v_pk_add_f32 v[232:233], v[36:37], v[38:39]
    v_lshlrev_b32 v36, 16, v255
    v_and_b32 v37, 0xffff0000, v255
    v_lshlrev_b32 v38, 16, v29
    v_and_b32 v39, 0xffff0000, v29
    v_pk_add_f32 v[234:235], v[36:37], v[38:39]
    s_waitcnt vmcnt(9)
    v_mfma_f32_16x16x32_bf16 v[60:63], a[4:7], v[120:123], 0
    buffer_load_dwordx4 v[160:163], v2, s[40:43], s53 offen offset:2048 sc1
    v_mfma_f32_16x16x32_bf16 v[64:67], a[8:11], v[120:123], 0
    v_mfma_f32_16x16x32_bf16 v[68:71], a[12:15], v[120:123], 0
    v_mfma_f32_16x16x32_bf16 v[72:75], a[16:19], v[120:123], 0
    v_mfma_f32_16x16x32_bf16 v[76:79], a[20:23], v[120:123], 0
    s_waitcnt vmcnt(9)
    v_mfma_f32_16x16x32_bf16 v[60:63], a[24:27], v[124:127], v[60:63]
    buffer_load_dwordx4 v[164:167], v2, s[40:43], s53 offen offset:3072 sc1
    v_mfma_f32_16x16x32_bf16 v[64:67], a[28:31], v[124:127], v[64:67]
    v_mfma_f32_16x16x32_bf16 v[68:71], a[32:35], v[124:127], v[68:71]
    v_mfma_f32_16x16x32_bf16 v[72:75], a[36:39], v[124:127], v[72:75]
    v_mfma_f32_16x16x32_bf16 v[76:79], a[40:43], v[124:127], v[76:79]
    s_waitcnt vmcnt(9)
    v_mfma_f32_16x16x32_bf16 v[60:63], a[44:47], v[128:131], v[60:63]
    buffer_load_dwordx4 v[168:171], v2, s[40:43], s54 offen offset:0 sc1
    v_mfma_f32_16x16x32_bf16 v[64:67], a[48:51], v[128:131], v[64:67]
    v_mfma_f32_16x16x32_bf16 v[68:71], a[52:55], v[128:131], v[68:71]
    v_mfma_f32_16x16x32_bf16 v[72:75], a[56:59], v[128:131], v[72:75]
    v_mfma_f32_16x16x32_bf16 v[76:79], a[60:63], v[128:131], v[76:79]
    s_waitcnt vmcnt(9)
    v_mfma_f32_16x16x32_bf16 v[60:63], a[64:67], v[132:135], v[60:63]
    buffer_load_dwordx4 v[172:175], v2, s[40:43], s54 offen offset:1024 sc1
    v_mfma_f32_16x16x32_bf16 v[64:67], a[68:71], v[132:135], v[64:67]
    v_mfma_f32_16x16x32_bf16 v[68:71], a[72:75], v[132:135], v[68:71]
    v_mfma_f32_16x16x32_bf16 v[72:75], a[76:79], v[132:135], v[72:75]
    v_mfma_f32_16x16x32_bf16 v[76:79], a[80:83], v[132:135], v[76:79]
    s_waitcnt vmcnt(9)
    v_mfma_f32_16x16x32_bf16 v[60:63], a[84:87], v[136:139], v[60:63]
    buffer_load_dwordx4 v[176:179], v2, s[40:43], s54 offen offset:2048 sc1
    v_mfma_f32_16x16x32_bf16 v[64:67], a[88:91], v[136:139], v[64:67]
    v_mfma_f32_16x16x32_bf16 v[68:71], a[92:95], v[136:139], v[68:71]
    v_mfma_f32_16x16x32_bf16 v[72:75], a[96:99], v[136:139], v[72:75]
    v_mfma_f32_16x16x32_bf16 v[76:79], a[100:103], v[136:139], v[76:79]
    s_waitcnt vmcnt(9)
    v_mfma_f32_16x16x32_bf16 v[60:63], a[104:107], v[140:143], v[60:63]
    buffer_load_dwordx4 v[180:183], v2, s[40:43], s54 offen offset:3072 sc1
    v_mfma_f32_16x16x32_bf16 v[64:67], a[108:111], v[140:143], v[64:67]
    s_add_u32 s54, s54, 4096
    v_mfma_f32_16x16x32_bf16 v[68:71], a[112:115], v[140:143], v[68:71]
    v_mfma_f32_16x16x32_bf16 v[72:75], a[116:119], v[140:143], v[72:75]
    v_mfma_f32_16x16x32_bf16 v[76:79], a[120:123], v[140:143], v[76:79]
    s_waitcnt vmcnt(9)
    v_mfma_f32_16x16x32_bf16 v[60:63], a[124:127], v[144:147], v[60:63]
    buffer_load_dwordx4 v[184:187], v2, s[40:43], s54 offen offset:0 sc1
    v_mfma_f32_16x16x32_bf16 v[64:67], a[128:131], v[144:147], v[64:67]
    v_mfma_f32_16x16x32_bf16 v[68:71], a[132:135], v[144:147], v[68:71]
    v_mfma_f32_16x16x32_bf16 v[72:75], a[136:139], v[144:147], v[72:75]
    v_mfma_f32_16x16x32_bf16 v[76:79], a[140:143], v[144:147], v[76:79]
    s_waitcnt vmcnt(9)
    v_mfma_f32_16x16x32_bf16 v[60:63], a[144:147], v[148:151], v[60:63]
    buffer_load_dwordx4 v[188:191], v2, s[40:43], s54 offen offset:1024 sc1
    v_mfma_f32_16x16x32_bf16 v[64:67], a[148:151], v[148:151], v[64:67]
    v_mfma_f32_16x16x32_bf16 v[68:71], a[152:155], v[148:151], v[68:71]
    v_mfma_f32_16x16x32_bf16 v[72:75], a[156:159], v[148:151], v[72:75]
    v_mfma_f32_16x16x32_bf16 v[76:79], a[160:163], v[148:151], v[76:79]
    s_waitcnt vmcnt(9)
    v_mfma_f32_16x16x32_bf16 v[60:63], a[164:167], v[152:155], v[60:63]
    buffer_load_dwordx4 v[192:195], v2, s[40:43], s54 offen offset:2048 sc1
    v_mfma_f32_16x16x32_bf16 v[64:67], a[168:171], v[152:155], v[64:67]
    v_mfma_f32_16x16x32_bf16 v[68:71], a[172:175], v[152:155], v[68:71]
    v_mfma_f32_16x16x32_bf16 v[72:75], a[176:179], v[152:155], v[72:75]
    v_mfma_f32_16x16x32_bf16 v[76:79], a[180:183], v[152:155], v[76:79]
    s_waitcnt vmcnt(9)
    v_mfma_f32_16x16x32_bf16 v[60:63], a[184:187], v[156:159], v[60:63]
    buffer_load_dwordx4 v[196:199], v2, s[40:43], s54 offen offset:3072 sc1
    v_mfma_f32_16x16x32_bf16 v[64:67], a[188:191], v[156:159], v[64:67]
    s_add_u32 s54, s54, 4096
    v_mfma_f32_16x16x32_bf16 v[68:71], a[192:195], v[156:159], v[68:71]
    v_mfma_f32_16x16x32_bf16 v[72:75], a[196:199], v[156:159], v[72:75]
    v_mfma_f32_16x16x32_bf16 v[76:79], a[200:203], v[156:159], v[76:79]
    s_waitcnt vmcnt(9)
    v_mfma_f32_16x16x32_bf16 v[60:63], a[204:207], v[160:163], v[60:63]
    buffer_load_dwordx4 v[200:203], v2, s[40:43], s54 offen offset:0 sc1
    v_mfma_f32_16x16x32_bf16 v[64:67], a[208:211], v[160:163], v[64:67]
    v_mfma_f32_16x16x32_bf16 v[68:71], a[212:215], v[160:163], v[68:71]
    v_mfma_f32_16x16x32_bf16 v[72:75], a[216:219], v[160:163], v[72:75]
    v_mfma_f32_16x16x32_bf16 v[76:79], a[220:223], v[160:163], v[76:79]
    s_waitcnt vmcnt(9)
    v_mfma_f32_16x16x32_bf16 v[60:63], a[224:227], v[164:167], v[60:63]
    buffer_load_dwordx4 v[204:207], v2, s[40:43], s54 offen offset:1024 sc1
    v_mfma_f32_16x16x32_bf16 v[64:67], a[228:231], v[164:167], v[64:67]
    v_mfma_f32_16x16x32_bf16 v[68:71], a[232:235], v[164:167], v[68:71]
    v_mfma_f32_16x16x32_bf16 v[72:75], a[236:239], v[164:167], v[72:75]
    v_mfma_f32_16x16x32_bf16 v[76:79], a[240:243], v[164:167], v[76:79]
    s_waitcnt vmcnt(9)
    v_mfma_f32_16x16x32_bf16 v[80:83], a[4:7], v[168:171], 0
    buffer_load_dwordx4 v[208:211], v2, s[40:43], s54 offen offset:2048 sc1
    v_mfma_f32_16x16x32_bf16 v[84:87], a[8:11], v[168:171], 0
    v_mfma_f32_16x16x32_bf16 v[88:91], a[12:15], v[168:171], 0
    v_mfma_f32_16x16x32_bf16 v[92:95], a[16:19], v[168:171], 0
    v_mfma_f32_16x16x32_bf16 v[96:99], a[20:23], v[168:171], 0
    s_waitcnt vmcnt(9)
    v_mfma_f32_16x16x32_bf16 v[80:83], a[24:27], v[172:175], v[80:83]
    buffer_load_dwordx4 v[212:215], v2, s[40:43], s54 offen offset:3072 sc1
    v_mfma_f32_16x16x32_bf16 v[84:87], a[28:31], v[172:175], v[84:87]
    v_mfma_f32_16x16x32_bf16 v[88:91], a[32:35], v[172:175], v[88:91]
    ds_write_b128 v13, v[60:63] offset:0
    v_mfma_f32_16x16x32_bf16 v[92:95], a[36:39], v[172:175], v[92:95]
    v_mfma_f32_16x16x32_bf16 v[96:99], a[40:43], v[172:175], v[96:99]
    s_waitcnt vmcnt(9)
    v_mfma_f32_16x16x32_bf16 v[80:83], a[44:47], v[176:179], v[80:83]
    buffer_load_dwordx4 v[120:123], v2, s[40:43], s55 offen offset:0 sc1
    v_mfma_f32_16x16x32_bf16 v[84:87], a[48:51], v[176:179], v[84:87]
    v_mfma_f32_16x16x32_bf16 v[88:91], a[52:55], v[176:179], v[88:91]
    v_mfma_f32_16x16x32_bf16 v[92:95], a[56:59], v[176:179], v[92:95]
    v_mfma_f32_16x16x32_bf16 v[96:99], a[60:63], v[176:179], v[96:99]
    s_waitcnt vmcnt(9)
    v_mfma_f32_16x16x32_bf16 v[80:83], a[64:67], v[180:183], v[80:83]
    buffer_load_dwordx4 v[124:127], v2, s[40:43], s55 offen offset:1024 sc1
    v_mfma_f32_16x16x32_bf16 v[84:87], a[68:71], v[180:183], v[84:87]
    v_mfma_f32_16x16x32_bf16 v[88:91], a[72:75], v[180:183], v[88:91]
    ds_write_b128 v13, v[64:67] offset:1024
    v_mfma_f32_16x16x32_bf16 v[92:95], a[76:79], v[180:183], v[92:95]
    v_mfma_f32_16x16x32_bf16 v[96:99], a[80:83], v[180:183], v[96:99]
    s_waitcnt vmcnt(9)
    v_mfma_f32_16x16x32_bf16 v[80:83], a[84:87], v[184:187], v[80:83]
    buffer_load_dwordx4 v[128:131], v2, s[40:43], s55 offen offset:2048 sc1
    v_mfma_f32_16x16x32_bf16 v[84:87], a[88:91], v[184:187], v[84:87]
    v_mfma_f32_16x16x32_bf16 v[88:91], a[92:95], v[184:187], v[88:91]
    v_mfma_f32_16x16x32_bf16 v[92:95], a[96:99], v[184:187], v[92:95]
    v_mfma_f32_16x16x32_bf16 v[96:99], a[100:103], v[184:187], v[96:99]
    s_waitcnt vmcnt(9)
    v_mfma_f32_16x16x32_bf16 v[80:83], a[104:107], v[188:191], v[80:83]
    buffer_load_dwordx4 v[132:135], v2, s[40:43], s55 offen offset:3072 sc1
    v_mfma_f32_16x16x32_bf16 v[84:87], a[108:111], v[188:191], v[84:87]
    s_add_u32 s55, s55, 4096
    v_mfma_f32_16x16x32_bf16 v[88:91], a[112:115], v[188:191], v[88:91]
    ds_write_b128 v13, v[68:71] offset:2048
    v_mfma_f32_16x16x32_bf16 v[92:95], a[116:119], v[188:191], v[92:95]
    v_mfma_f32_16x16x32_bf16 v[96:99], a[120:123], v[188:191], v[96:99]
    s_waitcnt vmcnt(9)
    v_mfma_f32_16x16x32_bf16 v[80:83], a[124:127], v[192:195], v[80:83]
    buffer_load_dwordx4 v[136:139], v2, s[40:43], s55 offen offset:0 sc1
    v_mfma_f32_16x16x32_bf16 v[84:87], a[128:131], v[192:195], v[84:87]
    v_mfma_f32_16x16x32_bf16 v[88:91], a[132:135], v[192:195], v[88:91]
    v_mfma_f32_16x16x32_bf16 v[92:95], a[136:139], v[192:195], v[92:95]
    v_mfma_f32_16x16x32_bf16 v[96:99], a[140:143], v[192:195], v[96:99]
    s_waitcnt vmcnt(9)
    v_mfma_f32_16x16x32_bf16 v[80:83], a[144:147], v[196:199], v[80:83]
    buffer_load_dwordx4 v[140:143], v2, s[40:43], s55 offen offset:1024 sc1
    v_mfma_f32_16x16x32_bf16 v[84:87], a[148:151], v[196:199], v[84:87]
    v_mfma_f32_16x16x32_bf16 v[88:91], a[152:155], v[196:199], v[88:91]
    ds_write_b128 v13, v[72:75] offset:3072
    v_mfma_f32_16x16x32_bf16 v[92:95], a[156:159], v[196:199], v[92:95]
    v_mfma_f32_16x16x32_bf16 v[96:99], a[160:163], v[196:199], v[96:99]
    s_waitcnt vmcnt(9)
    v_mfma_f32_16x16x32_bf16 v[80:83], a[164:167], v[200:203], v[80:83]
    buffer_load_dwordx4 v[144:147], v2, s[40:43], s55 offen offset:2048 sc1
    v_mfma_f32_16x16x32_bf16 v[84:87], a[168:171], v[200:203], v[84:87]
    v_mfma_f32_16x16x32_bf16 v[88:91], a[172:175], v[200:203], v[88:91]
    v_mfma_f32_16x16x32_bf16 v[92:95], a[176:179], v[200:203], v[92:95]
    v_mfma_f32_16x16x32_bf16 v[96:99], a[180:183], v[200:203], v[96:99]
    s_waitcnt vmcnt(9)
    v_mfma_f32_16x16x32_bf16 v[80:83], a[184:187], v[204:207], v[80:83]
    buffer_load_dwordx4 v[148:151], v2, s[40:43], s55 offen offset:3072 sc1
    v_mfma_f32_16x16x32_bf16 v[84:87], a[188:191], v[204:207], v[84:87]
    s_add_u32 s55, s55, 4096
    v_mfma_f32_16x16x32_bf16 v[88:91], a[192:195], v[204:207], v[88:91]
    ds_write_b128 v13, v[76:79] offset:4096
    v_mfma_f32_16x16x32_bf16 v[92:95], a[196:199], v[204:207], v[92:95]
    v_mfma_f32_16x16x32_bf16 v[96:99], a[200:203], v[204:207], v[96:99]
    s_waitcnt vmcnt(9)
    v_mfma_f32_16x16x32_bf16 v[80:83], a[204:207], v[208:211], v[80:83]
    buffer_load_dwordx4 v[152:155], v2, s[40:43], s55 offen offset:0 sc1
    v_mfma_f32_16x16x32_bf16 v[84:87], a[208:211], v[208:211], v[84:87]
    v_mfma_f32_16x16x32_bf16 v[88:91], a[212:215], v[208:211], v[88:91]
    v_mfma_f32_16x16x32_bf16 v[92:95], a[216:219], v[208:211], v[92:95]
    v_mfma_f32_16x16x32_bf16 v[96:99], a[220:223], v[208:211], v[96:99]
    s_waitcnt vmcnt(9)
    v_mfma_f32_16x16x32_bf16 v[80:83], a[224:227], v[212:215], v[80:83]
    buffer_load_dwordx4 v[156:159], v2, s[40:43], s55 offen offset:1024 sc1
    v_mfma_f32_16x16x32_bf16 v[84:87], a[228:231], v[212:215], v[84:87]
    v_mfma_f32_16x16x32_bf16 v[88:91], a[232:235], v[212:215], v[88:91]
    v_mfma_f32_16x16x32_bf16 v[92:95], a[236:239], v[212:215], v[92:95]
    v_mfma_f32_16x16x32_bf16 v[96:99], a[240:243], v[212:215], v[96:99]
    s_waitcnt vmcnt(9)
    v_mfma_f32_16x16x32_bf16 v[100:103], a[4:7], v[120:123], 0
    buffer_load_dwordx4 v[160:163], v2, s[40:43], s55 offen offset:2048 sc1
    v_mfma_f32_16x16x32_bf16 v[104:107], a[8:11], v[120:123], 0
    v_mfma_f32_16x16x32_bf16 v[108:111], a[12:15], v[120:123], 0
    v_mfma_f32_16x16x32_bf16 v[112:115], a[16:19], v[120:123], 0
    v_mfma_f32_16x16x32_bf16 v[116:119], a[20:23], v[120:123], 0
    s_waitcnt vmcnt(9)
    v_mfma_f32_16x16x32_bf16 v[100:103], a[24:27], v[124:127], v[100:103]
    buffer_load_dwordx4 v[164:167], v2, s[40:43], s55 offen offset:3072 sc1
    v_mfma_f32_16x16x32_bf16 v[104:107], a[28:31], v[124:127], v[104:107]
    v_mfma_f32_16x16x32_bf16 v[108:111], a[32:35], v[124:127], v[108:111]
    ds_write_b128 v14, v[80:83] offset:0
    v_mfma_f32_16x16x32_bf16 v[112:115], a[36:39], v[124:127], v[112:115]
    v_mfma_f32_16x16x32_bf16 v[116:119], a[40:43], v[124:127], v[116:119]
    s_waitcnt vmcnt(9)
    v_mfma_f32_16x16x32_bf16 v[100:103], a[44:47], v[128:131], v[100:103]
    buffer_load_dwordx4 v[168:171], v2, s[40:43], s52 offen offset:0 sc1
    v_mfma_f32_16x16x32_bf16 v[104:107], a[48:51], v[128:131], v[104:107]
    v_mfma_f32_16x16x32_bf16 v[108:111], a[52:55], v[128:131], v[108:111]
    v_mfma_f32_16x16x32_bf16 v[112:115], a[56:59], v[128:131], v[112:115]
    v_mfma_f32_16x16x32_bf16 v[116:119], a[60:63], v[128:131], v[116:119]
    s_waitcnt vmcnt(9)
    v_mfma_f32_16x16x32_bf16 v[100:103], a[64:67], v[132:135], v[100:103]
    buffer_load_dwordx4 v[172:175], v2, s[40:43], s52 offen offset:1024 sc1
    v_mfma_f32_16x16x32_bf16 v[104:107], a[68:71], v[132:135], v[104:107]
    v_mfma_f32_16x16x32_bf16 v[108:111], a[72:75], v[132:135], v[108:111]
    ds_write_b128 v14, v[84:87] offset:1024
    v_mfma_f32_16x16x32_bf16 v[112:115], a[76:79], v[132:135], v[112:115]
    v_mfma_f32_16x16x32_bf16 v[116:119], a[80:83], v[132:135], v[116:119]
    s_waitcnt vmcnt(9)
    v_mfma_f32_16x16x32_bf16 v[100:103], a[84:87], v[136:139], v[100:103]
    buffer_load_dwordx4 v[176:179], v2, s[40:43], s52 offen offset:2048 sc1
    v_mfma_f32_16x16x32_bf16 v[104:107], a[88:91], v[136:139], v[104:107]
    v_mfma_f32_16x16x32_bf16 v[108:111], a[92:95], v[136:139], v[108:111]
    v_mfma_f32_16x16x32_bf16 v[112:115], a[96:99], v[136:139], v[112:115]
    v_mfma_f32_16x16x32_bf16 v[116:119], a[100:103], v[136:139], v[116:119]
    s_waitcnt vmcnt(9)
    v_mfma_f32_16x16x32_bf16 v[100:103], a[104:107], v[140:143], v[100:103]
    buffer_load_dwordx4 v[180:183], v2, s[40:43], s52 offen offset:3072 sc1
    v_mfma_f32_16x16x32_bf16 v[104:107], a[108:111], v[140:143], v[104:107]
    s_add_u32 s52, s52, 4096
    v_mfma_f32_16x16x32_bf16 v[108:111], a[112:115], v[140:143], v[108:111]
    ds_write_b128 v14, v[88:91] offset:2048
    v_mfma_f32_16x16x32_bf16 v[112:115], a[116:119], v[140:143], v[112:115]
    v_mfma_f32_16x16x32_bf16 v[116:119], a[120:123], v[140:143], v[116:119]
    s_waitcnt vmcnt(9)
    v_mfma_f32_16x16x32_bf16 v[100:103], a[124:127], v[144:147], v[100:103]
    buffer_load_dwordx4 v[184:187], v2, s[40:43], s52 offen offset:0 sc1
    v_mfma_f32_16x16x32_bf16 v[104:107], a[128:131], v[144:147], v[104:107]
    v_mfma_f32_16x16x32_bf16 v[108:111], a[132:135], v[144:147], v[108:111]
    v_mfma_f32_16x16x32_bf16 v[112:115], a[136:139], v[144:147], v[112:115]
    v_mfma_f32_16x16x32_bf16 v[116:119], a[140:143], v[144:147], v[116:119]
    s_waitcnt vmcnt(9)
    v_mfma_f32_16x16x32_bf16 v[100:103], a[144:147], v[148:151], v[100:103]
    buffer_load_dwordx4 v[188:191], v2, s[40:43], s52 offen offset:1024 sc1
    v_mfma_f32_16x16x32_bf16 v[104:107], a[148:151], v[148:151], v[104:107]
    v_mfma_f32_16x16x32_bf16 v[108:111], a[152:155], v[148:151], v[108:111]
    ds_write_b128 v14, v[92:95] offset:3072
    v_mfma_f32_16x16x32_bf16 v[112:115], a[156:159], v[148:151], v[112:115]
    v_mfma_f32_16x16x32_bf16 v[116:119], a[160:163], v[148:151], v[116:119]
    s_waitcnt vmcnt(9)
    v_mfma_f32_16x16x32_bf16 v[100:103], a[164:167], v[152:155], v[100:103]
    buffer_load_dwordx4 v[192:195], v2, s[40:43], s52 offen offset:2048 sc1
    v_mfma_f32_16x16x32_bf16 v[104:107], a[168:171], v[152:155], v[104:107]
    v_mfma_f32_16x16x32_bf16 v[108:111], a[172:175], v[152:155], v[108:111]
    v_mfma_f32_16x16x32_bf16 v[112:115], a[176:179], v[152:155], v[112:115]
    v_mfma_f32_16x16x32_bf16 v[116:119], a[180:183], v[152:155], v[116:119]
    s_waitcnt vmcnt(9)
    v_mfma_f32_16x16x32_bf16 v[100:103], a[184:187], v[156:159], v[100:103]
    buffer_load_dwordx4 v[196:199], v2, s[40:43], s52 offen offset:3072 sc1
    v_mfma_f32_16x16x32_bf16 v[104:107], a[188:191], v[156:159], v[104:107]
    s_add_u32 s52, s52, 4096
    v_mfma_f32_16x16x32_bf16 v[108:111], a[192:195], v[156:159], v[108:111]
    ds_write_b128 v14, v[96:99] offset:4096
    v_mfma_f32_16x16x32_bf16 v[112:115], a[196:199], v[156:159], v[112:115]
    v_mfma_f32_16x16x32_bf16 v[116:119], a[200:203], v[156:159], v[116:119]
    s_waitcnt vmcnt(9)
    v_mfma_f32_16x16x32_bf16 v[100:103], a[204:207], v[160:163], v[100:103]
    buffer_load_dwordx4 v[200:203], v2, s[40:43], s52 offen offset:0 sc1
    v_mfma_f32_16x16x32_bf16 v[104:107], a[208:211], v[160:163], v[104:107]
    v_mfma_f32_16x16x32_bf16 v[108:111], a[212:215], v[160:163], v[108:111]
    v_mfma_f32_16x16x32_bf16 v[112:115], a[216:219], v[160:163], v[112:115]
    v_mfma_f32_16x16x32_bf16 v[116:119], a[220:223], v[160:163], v[116:119]
    s_waitcnt vmcnt(9)
    v_mfma_f32_16x16x32_bf16 v[100:103], a[224:227], v[164:167], v[100:103]
    buffer_load_dwordx4 v[204:207], v2, s[40:43], s52 offen offset:1024 sc1
    v_mfma_f32_16x16x32_bf16 v[104:107], a[228:231], v[164:167], v[104:107]
    v_mfma_f32_16x16x32_bf16 v[108:111], a[232:235], v[164:167], v[108:111]
    v_mfma_f32_16x16x32_bf16 v[112:115], a[236:239], v[164:167], v[112:115]
    v_mfma_f32_16x16x32_bf16 v[116:119], a[240:243], v[164:167], v[116:119]
    s_waitcnt vmcnt(9)
    v_mfma_f32_16x16x32_bf16 v[40:43], a[4:7], v[168:171], v[216:219]
    buffer_load_dwordx4 v[208:211], v2, s[40:43], s52 offen offset:2048 sc1
    v_mfma_f32_16x16x32_bf16 v[44:47], a[8:11], v[168:171], v[220:223]
    v_mfma_f32_16x16x32_bf16 v[48:51], a[12:15], v[168:171], v[224:227]
    v_mfma_f32_16x16x32_bf16 v[52:55], a[16:19], v[168:171], v[228:231]
    v_mfma_f32_16x16x32_bf16 v[56:59], a[20:23], v[168:171], v[232:235]
    s_waitcnt vmcnt(9)
    v_mfma_f32_16x16x32_bf16 v[40:43], a[24:27], v[172:175], v[40:43]
    buffer_load_dwordx4 v[212:215], v2, s[40:43], s52 offen offset:3072 sc1
    v_mfma_f32_16x16x32_bf16 v[44:47], a[28:31], v[172:175], v[44:47]
    v_mfma_f32_16x16x32_bf16 v[48:51], a[32:35], v[172:175], v[48:51]
    ds_write_b128 v15, v[100:103] offset:0
    v_mfma_f32_16x16x32_bf16 v[52:55], a[36:39], v[172:175], v[52:55]
    v_mfma_f32_16x16x32_bf16 v[56:59], a[40:43], v[172:175], v[56:59]
    s_waitcnt vmcnt(9)
    v_mfma_f32_16x16x32_bf16 v[40:43], a[44:47], v[176:179], v[40:43]
    v_mfma_f32_16x16x32_bf16 v[44:47], a[48:51], v[176:179], v[44:47]
    v_mfma_f32_16x16x32_bf16 v[48:51], a[52:55], v[176:179], v[48:51]
    v_mfma_f32_16x16x32_bf16 v[52:55], a[56:59], v[176:179], v[52:55]
    v_mfma_f32_16x16x32_bf16 v[56:59], a[60:63], v[176:179], v[56:59]
    s_waitcnt vmcnt(8)
    v_mfma_f32_16x16x32_bf16 v[40:43], a[64:67], v[180:183], v[40:43]
    v_mfma_f32_16x16x32_bf16 v[44:47], a[68:71], v[180:183], v[44:47]
    v_mfma_f32_16x16x32_bf16 v[48:51], a[72:75], v[180:183], v[48:51]
    ds_write_b128 v15, v[104:107] offset:1024
    v_mfma_f32_16x16x32_bf16 v[52:55], a[76:79], v[180:183], v[52:55]
    v_mfma_f32_16x16x32_bf16 v[56:59], a[80:83], v[180:183], v[56:59]
    s_waitcnt vmcnt(7)
    v_mfma_f32_16x16x32_bf16 v[40:43], a[84:87], v[184:187], v[40:43]
    v_mfma_f32_16x16x32_bf16 v[44:47], a[88:91], v[184:187], v[44:47]
    v_mfma_f32_16x16x32_bf16 v[48:51], a[92:95], v[184:187], v[48:51]
    v_mfma_f32_16x16x32_bf16 v[52:55], a[96:99], v[184:187], v[52:55]
    v_mfma_f32_16x16x32_bf16 v[56:59], a[100:103], v[184:187], v[56:59]
    s_waitcnt vmcnt(6)
    v_mfma_f32_16x16x32_bf16 v[40:43], a[104:107], v[188:191], v[40:43]
    v_mfma_f32_16x16x32_bf16 v[44:47], a[108:111], v[188:191], v[44:47]
    v_mfma_f32_16x16x32_bf16 v[48:51], a[112:115], v[188:191], v[48:51]
    ds_write_b128 v15, v[108:111] offset:2048
    v_mfma_f32_16x16x32_bf16 v[52:55], a[116:119], v[188:191], v[52:55]
    v_mfma_f32_16x16x32_bf16 v[56:59], a[120:123], v[188:191], v[56:59]
    s_waitcnt vmcnt(5)
    v_mfma_f32_16x16x32_bf16 v[40:43], a[124:127], v[192:195], v[40:43]
    v_mfma_f32_16x16x32_bf16 v[44:47], a[128:131], v[192:195], v[44:47]
    v_mfma_f32_16x16x32_bf16 v[48:51], a[132:135], v[192:195], v[48:51]
    v_mfma_f32_16x16x32_bf16 v[52:55], a[136:139], v[192:195], v[52:55]
    v_mfma_f32_16x16x32_bf16 v[56:59], a[140:143], v[192:195], v[56:59]
    s_waitcnt vmcnt(4)
    v_mfma_f32_16x16x32_bf16 v[40:43], a[144:147], v[196:199], v[40:43]
    v_mfma_f32_16x16x32_bf16 v[44:47], a[148:151], v[196:199], v[44:47]
    v_mfma_f32_16x16x32_bf16 v[48:51], a[152:155], v[196:199], v[48:51]
    ds_write_b128 v15, v[112:115] offset:3072
    v_mfma_f32_16x16x32_bf16 v[52:55], a[156:159], v[196:199], v[52:55]
    v_mfma_f32_16x16x32_bf16 v[56:59], a[160:163], v[196:199], v[56:59]
    s_waitcnt vmcnt(3)
    v_mfma_f32_16x16x32_bf16 v[40:43], a[164:167], v[200:203], v[40:43]
    v_mfma_f32_16x16x32_bf16 v[44:47], a[168:171], v[200:203], v[44:47]
    v_mfma_f32_16x16x32_bf16 v[48:51], a[172:175], v[200:203], v[48:51]
    v_mfma_f32_16x16x32_bf16 v[52:55], a[176:179], v[200:203], v[52:55]
    v_mfma_f32_16x16x32_bf16 v[56:59], a[180:183], v[200:203], v[56:59]
    s_waitcnt vmcnt(2)
    v_mfma_f32_16x16x32_bf16 v[40:43], a[184:187], v[204:207], v[40:43]
    v_mfma_f32_16x16x32_bf16 v[44:47], a[188:191], v[204:207], v[44:47]
    v_mfma_f32_16x16x32_bf16 v[48:51], a[192:195], v[204:207], v[48:51]
    ds_write_b128 v15, v[116:119] offset:4096
    v_mfma_f32_16x16x32_bf16 v[52:55], a[196:199], v[204:207], v[52:55]
    v_mfma_f32_16x16x32_bf16 v[56:59], a[200:203], v[204:207], v[56:59]
    s_waitcnt vmcnt(1)
    v_mfma_f32_16x16x32_bf16 v[40:43], a[204:207], v[208:211], v[40:43]
    v_mfma_f32_16x16x32_bf16 v[44:47], a[208:211], v[208:211], v[44:47]
    v_mfma_f32_16x16x32_bf16 v[48:51], a[212:215], v[208:211], v[48:51]
    v_mfma_f32_16x16x32_bf16 v[52:55], a[216:219], v[208:211], v[52:55]
    v_mfma_f32_16x16x32_bf16 v[56:59], a[220:223], v[208:211], v[56:59]
    s_waitcnt vmcnt(0)
    v_mfma_f32_16x16x32_bf16 v[40:43], a[224:227], v[212:215], v[40:43]
    v_mfma_f32_16x16x32_bf16 v[44:47], a[228:231], v[212:215], v[44:47]
    v_mfma_f32_16x16x32_bf16 v[48:51], a[232:235], v[212:215], v[48:51]
    v_mfma_f32_16x16x32_bf16 v[52:55], a[236:239], v[212:215], v[52:55]
    v_mfma_f32_16x16x32_bf16 v[56:59], a[240:243], v[212:215], v[56:59]
    s_waitcnt lgkmcnt(0)
    s_barrier
    ds_read_b128 v[120:123], v11 offset:0
    ds_read_b128 v[124:127], v11 offset:5120
    ds_read_b128 v[128:131], v11 offset:10240
    ds_read_b128 v[132:135], v11 offset:1024
    ds_read_b128 v[136:139], v11 offset:6144
    ds_read_b128 v[140:143], v11 offset:11264
    ds_read_b128 v[144:147], v11 offset:2048
    ds_read_b128 v[148:151], v11 offset:7168
    ds_read_b128 v[152:155], v11 offset:12288
    ds_read_b128 v[156:159], v11 offset:3072
    ds_read_b128 v[160:163], v11 offset:8192
    ds_read_b128 v[164:167], v11 offset:13312
    ds_read_b128 v[168:171], v11 offset:4096
    ds_read_b128 v[172:175], v11 offset:9216
    ds_read_b128 v[176:179], v11 offset:14336
    s_waitcnt lgkmcnt(12)
    v_pk_add_f32 v[40:41], v[40:41], v[120:121]
    v_pk_add_f32 v[124:125], v[124:125], v[128:129]
    v_pk_add_f32 v[42:43], v[42:43], v[122:123]
    v_pk_add_f32 v[126:127], v[126:127], v[130:131]
    v_pk_add_f32 v[40:41], v[40:41], v[124:125]
    v_pk_add_f32 v[42:43], v[42:43], v[126:127]
    v_cvt_pk_bf16_f32 v200, v40, v41
    v_cvt_pk_bf16_f32 v201, v42, v43
    ds_write_b64 v9, v[200:201] offset:0
    s_waitcnt lgkmcnt(9)
    v_pk_add_f32 v[44:45], v[44:45], v[132:133]
    v_pk_add_f32 v[136:137], v[136:137], v[140:141]
    v_pk_add_f32 v[46:47], v[46:47], v[134:135]
    v_pk_add_f32 v[138:139], v[138:139], v[142:143]
    v_pk_add_f32 v[44:45], v[44:45], v[136:137]
    v_pk_add_f32 v[46:47], v[46:47], v[138:139]
    v_cvt_pk_bf16_f32 v202, v44, v45
    v_cvt_pk_bf16_f32 v203, v46, v47
    ds_write_b64 v9, v[202:203] offset:32
    s_waitcnt lgkmcnt(6)
    v_pk_add_f32 v[48:49], v[48:49], v[144:145]
    v_pk_add_f32 v[148:149], v[148:149], v[152:153]
    v_pk_add_f32 v[50:51], v[50:51], v[146:147]
    v_pk_add_f32 v[150:151], v[150:151], v[154:155]
    v_pk_add_f32 v[48:49], v[48:49], v[148:149]
    v_pk_add_f32 v[50:51], v[50:51], v[150:151]
    v_cvt_pk_bf16_f32 v204, v48, v49
    v_cvt_pk_bf16_f32 v205, v50, v51
    ds_write_b64 v9, v[204:205] offset:64
    s_waitcnt lgkmcnt(3)
    v_pk_add_f32 v[52:53], v[52:53], v[156:157]
    v_pk_add_f32 v[160:161], v[160:161], v[164:165]
    v_pk_add_f32 v[54:55], v[54:55], v[158:159]
    v_pk_add_f32 v[162:163], v[162:163], v[166:167]
    v_pk_add_f32 v[52:53], v[52:53], v[160:161]
    v_pk_add_f32 v[54:55], v[54:55], v[162:163]
    v_cvt_pk_bf16_f32 v206, v52, v53
    v_cvt_pk_bf16_f32 v207, v54, v55
    ds_write_b64 v9, v[206:207] offset:96
    s_waitcnt lgkmcnt(0)
    v_pk_add_f32 v[56:57], v[56:57], v[168:169]
    v_pk_add_f32 v[172:173], v[172:173], v[176:177]
    v_pk_add_f32 v[58:59], v[58:59], v[170:171]
    v_pk_add_f32 v[174:175], v[174:175], v[178:179]
    v_pk_add_f32 v[56:57], v[56:57], v[172:173]
    v_pk_add_f32 v[58:59], v[58:59], v[174:175]
    v_cvt_pk_bf16_f32 v208, v56, v57
    v_cvt_pk_bf16_f32 v209, v58, v59
    ds_write_b64 v9, v[208:209] offset:128
    s_waitcnt lgkmcnt(0)
    ds_read_b128 v[120:123], v30
    ds_read_b128 v[124:127], v31
    ds_read_b128 v[128:131], v32
    s_waitcnt lgkmcnt(2)
    buffer_store_dwordx4 v[120:123], v33, s[36:39], s58 offen
    s_waitcnt lgkmcnt(1)
    buffer_store_dwordx4 v[124:127], v34, s[36:39], s58 offen
    s_waitcnt lgkmcnt(0)
    s_mov_b64 exec, 0xffffffff
    buffer_store_dwordx4 v[128:131], v35, s[36:39], s58 offen
L_end:
    s_endpgm
.section .rodata,"a"
.p2align 6
.amdhsa_kernel sequential_preLN__linear_attn_block__dense_activation_squared_relu__prompt_kernel
  .amdhsa_next_free_vgpr 512
  .amdhsa_next_free_sgpr 102
  .amdhsa_accum_offset 256
  .amdhsa_group_segment_fixed_size 0
  .amdhsa_kernarg_size 88
  .amdhsa_user_sgpr_count 2
  .amdhsa_user_sgpr_kernarg_segment_ptr 1
  .amdhsa_system_sgpr_workgroup_id_x 1
  .amdhsa_float_denorm_mode_32 3
.end_amdhsa_kernel
```
